```python
import torch

def _softmax(x, axis=-1):
    return torch.softmax(x, dim=axis)
def _gelu(x):
    return torch.nn.functional.gelu(x, approximate="tanh")
def _silu(x):
    return torch.nn.functional.silu(x)
def _sigmoid(x):
    return torch.sigmoid(x)
def _layernorm(x, axis=-1, eps=1e-5):
    m = x.mean(dim=axis, keepdim=True)
    v = x.var(dim=axis, keepdim=True, unbiased=False)
    return (x - m) / torch.sqrt(v + eps)
def _scatter_add(tgt, idx, src, axis=0):
    return tgt.clone().index_add_(axis, idx, src)
def _segment_sum(src, seg, n):
    out = torch.zeros((n,) + src.shape[1:], dtype=src.dtype)
    return out.index_add_(0, seg, src)
def _pad(x, pw):
    flat = tuple(v for pair in reversed(pw) for v in pair)
    return torch.nn.functional.pad(x, flat)

kernel_name = 'gated_mix__softmax_full_mha__dense_activation_mish__prompt'

def setup_inputs():

    _w = (lambda a: (lambda t: t.to(torch.bfloat16) if t.is_floating_point() else t)(torch.as_tensor(a)))
    def _A_setup():
        B, S, D = 1, 2048, 512
        return {
            "x": _w((lambda *s: torch.randn(*s, dtype=torch.bfloat16) * 0.05)(B, S, D)),
            "wqkv": _w((lambda *s: torch.randn(*s, dtype=torch.bfloat16) * 0.8)(D, 3 * D)),
            "wo": _w((lambda *s: torch.randn(*s, dtype=torch.bfloat16) * 0.05)(D, D)),
        }
    _A_in = _A_setup()

    def _B_setup():
        B, S, D, F = 1, 2048, 512, 1792
        return {
            "x": _w((lambda *s: torch.randn(*s, dtype=torch.bfloat16) * 0.05)(B, S, D)),
            "w1": _w((lambda *s: torch.randn(*s, dtype=torch.bfloat16) * 12.8)(D, F) * (D ** -0.5)),
            "b1": _w((lambda *s: torch.randn(*s, dtype=torch.bfloat16) * 0.2)(F)),
            "w2": _w((lambda *s: torch.randn(*s, dtype=torch.bfloat16) * 0.1)(F, D) * (F ** -0.5)),
        }
    _B_in = _B_setup()

    return {
        "A_x": _A_in["x"],
        "A_wqkv": _A_in["wqkv"],
        "A_wo": _A_in["wo"],
        "B_x": _B_in["x"],
        "B_w1": _B_in["w1"],
        "B_b1": _B_in["b1"],
        "B_w2": _B_in["w2"],
        "gate_w": _w((lambda *s: torch.randn(*s, dtype=torch.bfloat16) * 0.05)(512) * 16.0),
    }

def reference(A_x, A_wqkv, A_wo, B_x, B_w1, B_b1, B_w2, gate_w):
    def _A_ref(x, wqkv, wo):
        B, S, D = x.shape
        H = 32; Dh = D // H
        qkv = (lambda x, *d: x.permute(*d))((x @ wqkv).reshape(B, S, 3, H, Dh), 2, 0, 3, 1, 4)
        q, k, v = qkv[0], qkv[1], qkv[2]
        scale = Dh ** -0.5
        scores = torch.einsum("bhqd,bhkd->bhqk", q, k) * scale
        p = _softmax(scores, axis=-1)
        o = torch.einsum("bhqk,bhkd->bhqd", p, v)
        return (lambda x, *d: x.permute(*d))(o, 0, 2, 1, 3).reshape(B, S, D) @ wo

    def _B_ref(x, w1, b1, w2):
        h = torch.einsum("bsd,df->bsf", x, w1) + b1
        sp = torch.log1p(torch.exp(-torch.abs(h))) + torch.where(h > 0, h, torch.zeros_like(h))
        act = h * torch.tanh(sp)
        return torch.einsum("bsf,fd->bsd", act, w2)

    x = A_x
    g = _sigmoid((x * gate_w).sum(-1, keepdims=True))
    a = _A_ref(x, A_wqkv, A_wo)
    b = _B_ref(x, B_w1, B_b1, B_w2)
    return g * a + (1 - g) * b
```

```asm
; @launch grid=(256,1,1) block=(768,1,1) lds=163840
.amdgcn_target "amdgcn-amd-amdhsa--gfx950"
.text

.globl gated_mix__softmax_full_mha__dense_activation_mish__prompt_kernel
.p2align 8
.type gated_mix__softmax_full_mha__dense_activation_mish__prompt_kernel,@function
gated_mix__softmax_full_mha__dense_activation_mish__prompt_kernel:

    s_cmp_ge_u32 s2, 256
    s_cbranch_scc1 L_end
    s_getpc_b64 s[40:41]
L_pc0:
    v_lshlrev_b32 v1, 6, v0
    v_min_u32 v1, L_code_end-L_pc0-4, v1
    global_load_dword v96, v1, s[40:41]
    s_load_dwordx4 s[4:7], s[0:1], 0
    s_load_dwordx4 s[32:35], s[0:1], 32
    s_load_dwordx2 s[36:37], s[0:1], 56
    s_load_dwordx2 s[12:13], s[0:1], 72
    s_load_dwordx2 s[8:9], s[0:1], 80
    v_lshrrev_b32 v1, 6, v0
    v_and_b32 v0, 63, v0
    v_readfirstlane_b32 s16, v1
    s_and_b32 s21, s2, 7
    s_lshr_b32 s22, s2, 3
    s_and_b32 s18, s21, 1
    s_lshl_b32 s18, s18, 3
    s_and_b32 s23, s22, 7
    s_add_u32 s18, s18, s23
    s_lshr_b32 s19, s21, 1
    s_lshl_b32 s19, s19, 2
    s_lshr_b32 s23, s22, 3
    s_add_u32 s19, s19, s23
    s_and_b32 s17, s16, 3
    s_mov_b32 s10, 20971520
    s_mov_b32 s11, 0x00020000
    s_mov_b32 s14, 256
    s_mov_b32 s15, 0x00020000
    s_mov_b32 s20, 262144
    v_lshrrev_b32 v3, 4, v0
    s_cmp_lt_u32 s16, 8
    s_cbranch_scc1 L_comp
    s_setprio 2
    s_mov_b32 s46, 2097152
    s_mov_b32 s47, 0x00020000
    s_mov_b32 s50, 1572864
    s_mov_b32 s51, 0x00020000
    v_and_b32 v6, 7, v0
    v_xor_b32 v6, v6, v3
    v_lshlrev_b32 v6, 4, v6
    v_lshrrev_b32 v7, 3, v0
    v_lshl_add_u32 v10, v7, 10, v6
    v_xor_b32 v11, 64, v10
    v_add_u32 v11, 8192, v11
    s_lshl_b32 s25, s18, 17
    s_lshl_b32 s21, s17, 14
    s_add_u32 s25, s25, s21
    s_lshl_b32 s66, s17, 11
    s_mul_i32 s67, s17, 1536
    s_add_u32 s67, s67, 131072
    s_mul_i32 s26, s17, 24576
    s_lshl_b32 s21, s19, 7
    s_add_u32 s26, s26, s21
    s_and_b32 s22, s17, 1
    s_lshl_b32 s23, s19, 6
    s_sub_u32 s23, 1920, s23
    v_lshrrev_b32 v7, 1, v0
    v_add_u32 v7, 0, v7
    v_mul_u32_u24 v8, 0xaaab, v7
    v_lshrrev_b32 v8, 18, v8
    v_mul_u32_u24 v9, 6, v8
    v_sub_u32 v7, v7, v9
    v_xor_b32 v7, s22, v7
    v_mul_u32_u24 v8, 3072, v8
    v_lshl_add_u32 v8, v7, 5, v8
    v_lshrrev_b32 v9, 2, v7
    v_mul_u32_u24 v9, s23, v9
    v_add_u32 v8, v8, v9
    v_and_b32 v9, 1, v0
    v_lshl_add_u32 v14, v9, 4, v8
    v_lshrrev_b32 v7, 1, v0
    v_add_u32 v7, 32, v7
    v_mul_u32_u24 v8, 0xaaab, v7
    v_lshrrev_b32 v8, 18, v8
    v_mul_u32_u24 v9, 6, v8
    v_sub_u32 v7, v7, v9
    v_xor_b32 v7, s22, v7
    v_mul_u32_u24 v8, 3072, v8
    v_lshl_add_u32 v8, v7, 5, v8
    v_lshrrev_b32 v9, 2, v7
    v_mul_u32_u24 v9, s23, v9
    v_add_u32 v8, v8, v9
    v_and_b32 v9, 1, v0
    v_lshl_add_u32 v15, v9, 4, v8
    s_lshr_b32 s24, s2, 3
    s_and_b32 s24, s24, 7
    s_lshl_b32 s29, s24, 1
    s_waitcnt lgkmcnt(0)
    s_mov_b32 s44, s4
    s_mov_b32 s45, s5
    s_mov_b32 s48, s6
    s_mov_b32 s49, s7
    s_lshl_b32 s21, s24, 7
    s_add_u32 s60, s25, s21
    s_add_u32 m0, s66, 0
    s_nop 0
    buffer_load_dwordx4 v10, s[44:47], s60 offen lds
    s_add_u32 m0, s66, 1024
    s_nop 0
    buffer_load_dwordx4 v11, s[44:47], s60 offen lds
    s_mul_i32 s21, s29, 98304
    s_add_u32 s61, s26, s21
    s_add_u32 m0, s67, 0
    s_add_u32 s29, s29, 1
    buffer_load_dwordx4 v14, s[48:51], s61 offen lds
    s_add_u32 m0, s67, 1024
    s_mov_b32 exec_hi, 0
    buffer_load_dwordx4 v15, s[48:51], s61 offen lds
    s_mov_b32 exec_hi, -1
    s_and_b32 s29, s29, 15
    s_lshl_b32 s21, s24, 7
    s_add_u32 s60, s25, s21
    s_add_u32 m0, s66, 8192
    s_add_u32 s60, s60, 65536
    buffer_load_dwordx4 v10, s[44:47], s60 offen lds
    s_add_u32 m0, s66, 9216
    s_add_u32 s24, s24, 1
    buffer_load_dwordx4 v11, s[44:47], s60 offen lds
    s_and_b32 s24, s24, 7
    s_mul_i32 s21, s29, 98304
    s_add_u32 s61, s26, s21
    s_add_u32 m0, s67, 8192
    s_add_u32 s29, s29, 1
    buffer_load_dwordx4 v14, s[48:51], s61 offen lds
    s_add_u32 m0, s67, 9216
    s_mov_b32 exec_hi, 0
    buffer_load_dwordx4 v15, s[48:51], s61 offen lds
    s_mov_b32 exec_hi, -1
    s_and_b32 s29, s29, 15
    s_lshl_b32 s21, s24, 7
    s_add_u32 s60, s25, s21
    s_add_u32 m0, s66, 16384
    s_nop 0
    buffer_load_dwordx4 v10, s[44:47], s60 offen lds
    s_add_u32 m0, s66, 17408
    s_nop 0
    buffer_load_dwordx4 v11, s[44:47], s60 offen lds
    s_mul_i32 s21, s29, 98304
    s_add_u32 s61, s26, s21
    s_add_u32 m0, s67, 16384
    s_add_u32 s29, s29, 1
    buffer_load_dwordx4 v14, s[48:51], s61 offen lds
    s_add_u32 m0, s67, 17408
    s_mov_b32 exec_hi, 0
    buffer_load_dwordx4 v15, s[48:51], s61 offen lds
    s_mov_b32 exec_hi, -1
    s_and_b32 s29, s29, 15
    s_lshl_b32 s21, s24, 7
    s_add_u32 s60, s25, s21
    s_add_u32 m0, s66, 24576
    s_add_u32 s60, s60, 65536
    buffer_load_dwordx4 v10, s[44:47], s60 offen lds
    s_add_u32 m0, s66, 25600
    s_add_u32 s24, s24, 1
    buffer_load_dwordx4 v11, s[44:47], s60 offen lds
    s_and_b32 s24, s24, 7
    s_mul_i32 s21, s29, 98304
    s_add_u32 s61, s26, s21
    s_add_u32 m0, s67, 24576
    s_add_u32 s29, s29, 1
    buffer_load_dwordx4 v14, s[48:51], s61 offen lds
    s_add_u32 m0, s67, 25600
    s_mov_b32 exec_hi, 0
    buffer_load_dwordx4 v15, s[48:51], s61 offen lds
    s_mov_b32 exec_hi, -1
    s_and_b32 s29, s29, 15
    s_or_b32 s21, s2, s17
    s_cmp_lg_u32 s21, 0
    s_cbranch_scc1 L_noep
    s_memrealtime s[42:43]
    v_mov_b32 v6, 0
    s_waitcnt lgkmcnt(0)
    s_or_b32 s42, s42, 1
    v_mov_b32 v36, s42
    v_mov_b32 v37, s43
    s_mov_b64 exec, 1
    buffer_store_dwordx2 v[36:37], v6, s[12:15], 0 offen sc1
    s_mov_b64 exec, -1
    s_waitcnt vmcnt(0)
L_noep:
    s_mov_b32 s52, s32
    s_mov_b32 s53, s33
    s_mov_b32 s54, 1835008
    s_mov_b32 s55, 0x00020000
    s_add_u32 s68, s66, 131072
    s_mul_i32 s27, s17, 28672
    s_mul_i32 s21, s19, 224
    s_add_u32 s27, s27, s21
    s_and_b32 s22, s17, 1
    s_lshl_b32 s22, s22, 2
    v_lshrrev_b32 v7, 1, v0
    v_sub_u32 v7, v7, v3
    v_subrev_u32 v7, s22, v7
    v_and_b32 v7, 7, v7
    v_min_u32 v7, 6, v7
    v_mul_u32_u24 v8, 3584, v3
    v_lshl_add_u32 v8, v7, 5, v8
    v_and_b32 v9, 1, v0
    v_lshl_add_u32 v12, v9, 4, v8
    v_add_u32 v13, 14336, v12
    s_waitcnt vmcnt(10)
    s_barrier
    s_lshl_b32 s21, s24, 7
    s_add_u32 s60, s25, s21
    s_add_u32 m0, s66, 32768
    s_nop 0
    buffer_load_dwordx4 v10, s[44:47], s60 offen lds
    s_add_u32 m0, s66, 33792
    s_nop 0
    buffer_load_dwordx4 v11, s[44:47], s60 offen lds
    s_waitcnt vmcnt(10)
    s_barrier
    s_mul_i32 s21, s29, 98304
    s_add_u32 s61, s26, s21
    s_add_u32 m0, s67, 0
    s_add_u32 s29, s29, 1
    buffer_load_dwordx4 v14, s[48:51], s61 offen lds
    s_add_u32 m0, s67, 1024
    s_mov_b32 exec_hi, 0
    buffer_load_dwordx4 v15, s[48:51], s61 offen lds
    s_mov_b32 exec_hi, -1
    s_and_b32 s29, s29, 15
    s_lshl_b32 s21, s24, 7
    s_add_u32 s60, s25, s21
    s_add_u32 m0, s66, 40960
    s_add_u32 s60, s60, 65536
    buffer_load_dwordx4 v10, s[44:47], s60 offen lds
    s_add_u32 m0, s66, 41984
    s_add_u32 s24, s24, 1
    buffer_load_dwordx4 v11, s[44:47], s60 offen lds
    s_and_b32 s24, s24, 7
    s_waitcnt vmcnt(8)
    s_barrier
    s_mul_i32 s21, s29, 98304
    s_add_u32 s61, s26, s21
    s_add_u32 m0, s67, 8192
    s_add_u32 s29, s29, 1
    buffer_load_dwordx4 v14, s[48:51], s61 offen lds
    s_add_u32 m0, s67, 9216
    s_mov_b32 exec_hi, 0
    buffer_load_dwordx4 v15, s[48:51], s61 offen lds
    s_mov_b32 exec_hi, -1
    s_and_b32 s29, s29, 15
    s_lshl_b32 s21, s24, 7
    s_add_u32 s60, s25, s21
    s_add_u32 m0, s66, 49152
    s_nop 0
    buffer_load_dwordx4 v10, s[44:47], s60 offen lds
    s_add_u32 m0, s66, 50176
    s_nop 0
    buffer_load_dwordx4 v11, s[44:47], s60 offen lds
    s_waitcnt vmcnt(10)
    s_barrier
    s_mul_i32 s21, s29, 98304
    s_add_u32 s61, s26, s21
    s_add_u32 m0, s67, 16384
    s_add_u32 s29, s29, 1
    buffer_load_dwordx4 v14, s[48:51], s61 offen lds
    s_add_u32 m0, s67, 17408
    s_mov_b32 exec_hi, 0
    buffer_load_dwordx4 v15, s[48:51], s61 offen lds
    s_mov_b32 exec_hi, -1
    s_and_b32 s29, s29, 15
    s_lshl_b32 s21, s24, 7
    s_add_u32 s60, s25, s21
    s_add_u32 m0, s66, 57344
    s_add_u32 s60, s60, 65536
    buffer_load_dwordx4 v10, s[44:47], s60 offen lds
    s_add_u32 m0, s66, 58368
    s_add_u32 s24, s24, 1
    buffer_load_dwordx4 v11, s[44:47], s60 offen lds
    s_and_b32 s24, s24, 7
    s_waitcnt vmcnt(8)
    s_barrier
    s_mul_i32 s21, s29, 98304
    s_add_u32 s61, s26, s21
    s_add_u32 m0, s67, 24576
    s_add_u32 s29, s29, 1
    buffer_load_dwordx4 v14, s[48:51], s61 offen lds
    s_add_u32 m0, s67, 25600
    s_mov_b32 exec_hi, 0
    buffer_load_dwordx4 v15, s[48:51], s61 offen lds
    s_mov_b32 exec_hi, -1
    s_and_b32 s29, s29, 15
    s_lshl_b32 s21, s24, 7
    s_add_u32 s60, s25, s21
    s_add_u32 m0, s66, 65536
    s_nop 0
    buffer_load_dwordx4 v10, s[44:47], s60 offen lds
    s_add_u32 m0, s66, 66560
    s_nop 0
    buffer_load_dwordx4 v11, s[44:47], s60 offen lds
    s_waitcnt vmcnt(10)
    s_barrier
    s_mul_i32 s21, s29, 98304
    s_add_u32 s61, s26, s21
    s_add_u32 m0, s67, 0
    s_add_u32 s29, s29, 1
    buffer_load_dwordx4 v14, s[48:51], s61 offen lds
    s_add_u32 m0, s67, 1024
    s_mov_b32 exec_hi, 0
    buffer_load_dwordx4 v15, s[48:51], s61 offen lds
    s_mov_b32 exec_hi, -1
    s_and_b32 s29, s29, 15
    s_lshl_b32 s21, s24, 7
    s_add_u32 s60, s25, s21
    s_add_u32 m0, s66, 73728
    s_add_u32 s60, s60, 65536
    buffer_load_dwordx4 v10, s[44:47], s60 offen lds
    s_add_u32 m0, s66, 74752
    s_add_u32 s24, s24, 1
    buffer_load_dwordx4 v11, s[44:47], s60 offen lds
    s_and_b32 s24, s24, 7
    s_waitcnt vmcnt(8)
    s_barrier
    s_mul_i32 s21, s29, 98304
    s_add_u32 s61, s26, s21
    s_add_u32 m0, s67, 8192
    s_add_u32 s29, s29, 1
    buffer_load_dwordx4 v14, s[48:51], s61 offen lds
    s_add_u32 m0, s67, 9216
    s_mov_b32 exec_hi, 0
    buffer_load_dwordx4 v15, s[48:51], s61 offen lds
    s_mov_b32 exec_hi, -1
    s_and_b32 s29, s29, 15
    s_lshl_b32 s21, s24, 7
    s_add_u32 s60, s25, s21
    s_add_u32 m0, s66, 81920
    s_nop 0
    buffer_load_dwordx4 v10, s[44:47], s60 offen lds
    s_add_u32 m0, s66, 82944
    s_nop 0
    buffer_load_dwordx4 v11, s[44:47], s60 offen lds
    s_mov_b32 s56, s36
    s_mov_b32 s57, s37
    s_mov_b32 s58, 1024
    s_mov_b32 s59, 0x00020000
    s_lshl_b32 s21, s18, 7
    s_lshl_b32 s22, s19, 3
    s_add_u32 s21, s21, s22
    s_lshl_b32 s22, s17, 1
    s_add_u32 s63, s21, s22
    s_lshl_b32 s22, s63, 10
    v_and_b32 v7, 31, v0
    v_lshlrev_b32 v7, 5, v7
    v_lshrrev_b32 v8, 5, v0
    v_lshl_add_u32 v8, v8, 10, v7
    buffer_load_dwordx4 v[20:23], v8, s[44:47], s22 offen
    buffer_load_dwordx4 v[24:27], v8, s[44:47], s22 offen offset:16
    buffer_load_dwordx4 v[28:31], v7, s[56:59], 0 offen
    buffer_load_dwordx4 v[32:35], v7, s[56:59], 0 offen offset:16
    s_waitcnt vmcnt(14)
    s_barrier
    s_mul_i32 s21, s29, 98304
    s_add_u32 s61, s26, s21
    s_add_u32 m0, s67, 16384
    s_add_u32 s29, s29, 1
    buffer_load_dwordx4 v14, s[48:51], s61 offen lds
    s_add_u32 m0, s67, 17408
    s_mov_b32 exec_hi, 0
    buffer_load_dwordx4 v15, s[48:51], s61 offen lds
    s_mov_b32 exec_hi, -1
    s_and_b32 s29, s29, 15
    s_lshl_b32 s21, s24, 7
    s_add_u32 s60, s25, s21
    s_add_u32 m0, s66, 90112
    s_add_u32 s60, s60, 65536
    buffer_load_dwordx4 v10, s[44:47], s60 offen lds
    s_add_u32 m0, s66, 91136
    s_add_u32 s24, s24, 1
    buffer_load_dwordx4 v11, s[44:47], s60 offen lds
    s_and_b32 s24, s24, 7
    s_waitcnt vmcnt(12)
    s_barrier
    s_mul_i32 s21, s29, 98304
    s_add_u32 s61, s26, s21
    s_add_u32 m0, s67, 24576
    s_add_u32 s29, s29, 1
    buffer_load_dwordx4 v14, s[48:51], s61 offen lds
    s_add_u32 m0, s67, 25600
    s_mov_b32 exec_hi, 0
    buffer_load_dwordx4 v15, s[48:51], s61 offen lds
    s_mov_b32 exec_hi, -1
    s_and_b32 s29, s29, 15
    s_lshl_b32 s21, s24, 7
    s_add_u32 s60, s25, s21
    s_add_u32 m0, s66, 98304
    s_nop 0
    buffer_load_dwordx4 v10, s[44:47], s60 offen lds
    s_add_u32 m0, s66, 99328
    s_nop 0
    buffer_load_dwordx4 v11, s[44:47], s60 offen lds
    s_waitcnt vmcnt(14)
    s_barrier
    s_mul_i32 s21, s29, 98304
    s_add_u32 s61, s26, s21
    s_add_u32 m0, s67, 0
    s_add_u32 s29, s29, 1
    buffer_load_dwordx4 v14, s[48:51], s61 offen lds
    s_add_u32 m0, s67, 1024
    s_mov_b32 exec_hi, 0
    buffer_load_dwordx4 v15, s[48:51], s61 offen lds
    s_mov_b32 exec_hi, -1
    s_and_b32 s29, s29, 15
    s_lshl_b32 s21, s24, 7
    s_add_u32 s60, s25, s21
    s_add_u32 m0, s66, 106496
    s_add_u32 s60, s60, 65536
    buffer_load_dwordx4 v10, s[44:47], s60 offen lds
    s_add_u32 m0, s66, 107520
    s_add_u32 s24, s24, 1
    buffer_load_dwordx4 v11, s[44:47], s60 offen lds
    s_and_b32 s24, s24, 7
    s_waitcnt vmcnt(8)
    s_barrier
    s_mul_i32 s21, s29, 98304
    s_add_u32 s61, s26, s21
    s_add_u32 m0, s67, 8192
    s_add_u32 s29, s29, 1
    buffer_load_dwordx4 v14, s[48:51], s61 offen lds
    s_add_u32 m0, s67, 9216
    s_mov_b32 exec_hi, 0
    buffer_load_dwordx4 v15, s[48:51], s61 offen lds
    s_mov_b32 exec_hi, -1
    s_and_b32 s29, s29, 15
    s_lshl_b32 s21, s24, 7
    s_add_u32 s60, s25, s21
    s_add_u32 m0, s66, 114688
    s_nop 0
    buffer_load_dwordx4 v10, s[44:47], s60 offen lds
    s_add_u32 m0, s66, 115712
    s_nop 0
    buffer_load_dwordx4 v11, s[44:47], s60 offen lds
    s_waitcnt vmcnt(10)
    s_barrier
    s_mul_i32 s21, s29, 98304
    s_add_u32 s61, s26, s21
    s_add_u32 m0, s67, 16384
    s_add_u32 s29, s29, 1
    buffer_load_dwordx4 v14, s[48:51], s61 offen lds
    s_add_u32 m0, s67, 17408
    s_mov_b32 exec_hi, 0
    buffer_load_dwordx4 v15, s[48:51], s61 offen lds
    s_mov_b32 exec_hi, -1
    s_and_b32 s29, s29, 15
    s_lshl_b32 s21, s24, 7
    s_add_u32 s60, s25, s21
    s_add_u32 m0, s66, 122880
    s_add_u32 s60, s60, 65536
    buffer_load_dwordx4 v10, s[44:47], s60 offen lds
    s_add_u32 m0, s66, 123904
    s_add_u32 s24, s24, 1
    buffer_load_dwordx4 v11, s[44:47], s60 offen lds
    s_and_b32 s24, s24, 7
    s_waitcnt vmcnt(20)
    v_mov_b32 v7, 0
    v_dot2_f32_bf16 v7, v20, v28, v7
    v_dot2_f32_bf16 v7, v21, v29, v7
    v_dot2_f32_bf16 v7, v22, v30, v7
    v_dot2_f32_bf16 v7, v23, v31, v7
    v_dot2_f32_bf16 v7, v24, v32, v7
    v_dot2_f32_bf16 v7, v25, v33, v7
    v_dot2_f32_bf16 v7, v26, v34, v7
    v_dot2_f32_bf16 v7, v27, v35, v7
    s_nop 3
    v_add_f32_dpp v7, v7, v7 quad_perm:[1,0,3,2] row_mask:0xf bank_mask:0xf
    s_nop 1
    v_add_f32_dpp v7, v7, v7 quad_perm:[2,3,0,1] row_mask:0xf bank_mask:0xf
    s_nop 1
    v_add_f32_dpp v7, v7, v7 row_half_mirror row_mask:0xf bank_mask:0xf
    s_nop 1
    v_add_f32_dpp v7, v7, v7 row_mirror row_mask:0xf bank_mask:0xf
    v_mov_b32 v8, v7
    v_mov_b32 v9, v7
    s_nop 1
    v_permlane16_swap_b32 v8, v9
    v_add_f32 v7, v8, v9
    v_mul_f32 v7, 0xbfb8aa3b, v7
    v_exp_f32 v7, v7
    s_nop 0
    v_add_f32 v7, 1.0, v7
    v_rcp_f32 v7, v7
    s_lshl_b32 s21, s63, 2
    s_add_u32 s21, s21, 8388608
    v_lshrrev_b32 v8, 5, v0
    v_lshlrev_b32 v8, 2, v8
    s_mov_b32 exec_lo, 1
    s_mov_b32 exec_hi, 1
    buffer_store_dword v7, v8, s[8:11], s21 offen sc1
    s_mov_b64 exec, -1
    s_waitcnt vmcnt(9)
    s_barrier
    s_mul_i32 s21, s29, 98304
    s_add_u32 s61, s26, s21
    s_add_u32 m0, s67, 24576
    s_add_u32 s29, s29, 1
    buffer_load_dwordx4 v14, s[48:51], s61 offen lds
    s_add_u32 m0, s67, 25600
    s_mov_b32 exec_hi, 0
    buffer_load_dwordx4 v15, s[48:51], s61 offen lds
    s_mov_b32 exec_hi, -1
    s_and_b32 s29, s29, 15
    s_waitcnt vmcnt(9)
    s_barrier
    s_mul_i32 s21, s29, 114688
    s_add_u32 s61, s27, s21
    s_add_u32 m0, s68, 0
    s_add_u32 s29, s29, 1
    buffer_load_dwordx4 v12, s[52:55], s61 offen lds
    s_add_u32 m0, s68, 1024
    s_nop 0
    buffer_load_dwordx4 v13, s[52:55], s61 offen lds
    s_and_b32 s29, s29, 15
    s_waitcnt vmcnt(5)
    s_barrier
    s_mul_i32 s21, s29, 114688
    s_add_u32 s61, s27, s21
    s_add_u32 m0, s68, 8192
    s_add_u32 s29, s29, 1
    buffer_load_dwordx4 v12, s[52:55], s61 offen lds
    s_add_u32 m0, s68, 9216
    s_nop 0
    buffer_load_dwordx4 v13, s[52:55], s61 offen lds
    s_and_b32 s29, s29, 15
    s_waitcnt vmcnt(4)
    s_barrier
    s_mul_i32 s21, s29, 114688
    s_add_u32 s61, s27, s21
    s_add_u32 m0, s68, 16384
    s_add_u32 s29, s29, 1
    buffer_load_dwordx4 v12, s[52:55], s61 offen lds
    s_add_u32 m0, s68, 17408
    s_nop 0
    buffer_load_dwordx4 v13, s[52:55], s61 offen lds
    s_and_b32 s29, s29, 15
    s_waitcnt vmcnt(4)
    s_barrier
    s_mul_i32 s21, s29, 114688
    s_add_u32 s61, s27, s21
    s_add_u32 m0, s68, 24576
    s_add_u32 s29, s29, 1
    buffer_load_dwordx4 v12, s[52:55], s61 offen lds
    s_add_u32 m0, s68, 25600
    s_nop 0
    buffer_load_dwordx4 v13, s[52:55], s61 offen lds
    s_and_b32 s29, s29, 15
    s_waitcnt vmcnt(4)
    s_barrier
    s_mul_i32 s21, s29, 114688
    s_add_u32 s61, s27, s21
    s_add_u32 m0, s68, 0
    s_add_u32 s29, s29, 1
    buffer_load_dwordx4 v12, s[52:55], s61 offen lds
    s_add_u32 m0, s68, 1024
    s_nop 0
    buffer_load_dwordx4 v13, s[52:55], s61 offen lds
    s_and_b32 s29, s29, 15
    s_waitcnt vmcnt(4)
    s_barrier
    s_mul_i32 s21, s29, 114688
    s_add_u32 s61, s27, s21
    s_add_u32 m0, s68, 8192
    s_add_u32 s29, s29, 1
    buffer_load_dwordx4 v12, s[52:55], s61 offen lds
    s_add_u32 m0, s68, 9216
    s_nop 0
    buffer_load_dwordx4 v13, s[52:55], s61 offen lds
    s_and_b32 s29, s29, 15
    s_waitcnt vmcnt(4)
    s_barrier
    s_mul_i32 s21, s29, 114688
    s_add_u32 s61, s27, s21
    s_add_u32 m0, s68, 16384
    s_add_u32 s29, s29, 1
    buffer_load_dwordx4 v12, s[52:55], s61 offen lds
    s_add_u32 m0, s68, 17408
    s_nop 0
    buffer_load_dwordx4 v13, s[52:55], s61 offen lds
    s_and_b32 s29, s29, 15
    s_waitcnt vmcnt(4)
    s_barrier
    s_mul_i32 s21, s29, 114688
    s_add_u32 s61, s27, s21
    s_add_u32 m0, s68, 24576
    s_add_u32 s29, s29, 1
    buffer_load_dwordx4 v12, s[52:55], s61 offen lds
    s_add_u32 m0, s68, 25600
    s_nop 0
    buffer_load_dwordx4 v13, s[52:55], s61 offen lds
    s_and_b32 s29, s29, 15
    s_waitcnt vmcnt(4)
    s_barrier
    s_mul_i32 s21, s29, 114688
    s_add_u32 s61, s27, s21
    s_add_u32 m0, s68, 0
    s_add_u32 s29, s29, 1
    buffer_load_dwordx4 v12, s[52:55], s61 offen lds
    s_add_u32 m0, s68, 1024
    s_nop 0
    buffer_load_dwordx4 v13, s[52:55], s61 offen lds
    s_and_b32 s29, s29, 15
    s_waitcnt vmcnt(4)
    s_barrier
    s_mul_i32 s21, s29, 114688
    s_add_u32 s61, s27, s21
    s_add_u32 m0, s68, 8192
    s_add_u32 s29, s29, 1
    buffer_load_dwordx4 v12, s[52:55], s61 offen lds
    s_add_u32 m0, s68, 9216
    s_nop 0
    buffer_load_dwordx4 v13, s[52:55], s61 offen lds
    s_and_b32 s29, s29, 15
    s_waitcnt vmcnt(4)
    s_barrier
    s_mul_i32 s21, s29, 114688
    s_add_u32 s61, s27, s21
    s_add_u32 m0, s68, 16384
    s_add_u32 s29, s29, 1
    buffer_load_dwordx4 v12, s[52:55], s61 offen lds
    s_add_u32 m0, s68, 17408
    s_nop 0
    buffer_load_dwordx4 v13, s[52:55], s61 offen lds
    s_and_b32 s29, s29, 15
    s_waitcnt vmcnt(4)
    s_barrier
    s_mul_i32 s21, s29, 114688
    s_add_u32 s61, s27, s21
    s_add_u32 m0, s68, 24576
    s_add_u32 s29, s29, 1
    buffer_load_dwordx4 v12, s[52:55], s61 offen lds
    s_add_u32 m0, s68, 25600
    s_nop 0
    buffer_load_dwordx4 v13, s[52:55], s61 offen lds
    s_and_b32 s29, s29, 15
    s_waitcnt vmcnt(4)
    s_barrier
    s_mul_i32 s21, s29, 114688
    s_add_u32 s61, s27, s21
    s_add_u32 m0, s68, 0
    s_add_u32 s29, s29, 1
    buffer_load_dwordx4 v12, s[52:55], s61 offen lds
    s_add_u32 m0, s68, 1024
    s_nop 0
    buffer_load_dwordx4 v13, s[52:55], s61 offen lds
    s_and_b32 s29, s29, 15
    s_waitcnt vmcnt(4)
    s_barrier
    s_mul_i32 s21, s29, 114688
    s_add_u32 s61, s27, s21
    s_add_u32 m0, s68, 8192
    s_add_u32 s29, s29, 1
    buffer_load_dwordx4 v12, s[52:55], s61 offen lds
    s_add_u32 m0, s68, 9216
    s_nop 0
    buffer_load_dwordx4 v13, s[52:55], s61 offen lds
    s_and_b32 s29, s29, 15
    s_waitcnt vmcnt(4)
    s_barrier
    s_mul_i32 s21, s29, 114688
    s_add_u32 s61, s27, s21
    s_add_u32 m0, s68, 16384
    s_add_u32 s29, s29, 1
    buffer_load_dwordx4 v12, s[52:55], s61 offen lds
    s_add_u32 m0, s68, 17408
    s_nop 0
    buffer_load_dwordx4 v13, s[52:55], s61 offen lds
    s_and_b32 s29, s29, 15
    s_waitcnt vmcnt(4)
    s_barrier
    s_mul_i32 s21, s29, 114688
    s_add_u32 s61, s27, s21
    s_add_u32 m0, s68, 24576
    s_add_u32 s29, s29, 1
    buffer_load_dwordx4 v12, s[52:55], s61 offen lds
    s_add_u32 m0, s68, 25600
    s_nop 0
    buffer_load_dwordx4 v13, s[52:55], s61 offen lds
    s_and_b32 s29, s29, 15
    v_mov_b32 v6, 0
    buffer_load_dwordx2 v[154:155], v6, s[12:15], 0 offen sc1
    s_waitcnt vmcnt(5)
    s_barrier
    s_waitcnt vmcnt(3)
    s_barrier
    s_waitcnt vmcnt(1)
    s_barrier
    v_lshlrev_b32 v6, 2, v0
    v_add_u32 v6, 147456, v6
    v_mov_b32 v7, 0
    ds_write_b32 v6, v7
    s_waitcnt lgkmcnt(0)
    s_barrier
    s_setprio 0
    s_load_dwordx2 s[24:25], s[0:1], 48
    s_load_dwordx2 s[44:45], s[0:1], 16
    s_load_dwordx2 s[28:29], s[0:1], 64
    s_mov_b32 s26, 1835008
    s_mov_b32 s27, 0x00020000
    s_mov_b32 s30, 2097152
    s_mov_b32 s31, 0x00020000
    s_and_b32 s35, s17, 1
    s_lshr_b32 s36, s17, 1
    v_lshlrev_b32 v1, 4, v0
    s_and_b32 s21, s2, 7
    s_lshl_b32 s37, s21, 2
    s_bfe_u32 s21, s2, 0x20003
    s_add_u32 s37, s37, s21
    s_lshr_b32 s38, s2, 5
    s_mul_i32 s21, s37, 224
    s_mul_i32 s22, s17, 28
    s_add_u32 s21, s21, s22
    s_lshl_b32 s39, s21, 10
    s_add_u32 s39, s39, 12582912
    s_lshl_b32 s40, s22, 14
    s_lshl_b32 s23, s38, 7
    s_add_u32 s40, s40, s23
    s_mul_i32 s42, s17, 12288
    s_add_u32 s42, s42, 98304
    s_mul_i32 s21, s35, 114688
    s_sub_u32 s22, 114688, s21
    v_add_u32 v12, s21, v1
    v_add_u32 v13, s22, v1
    v_lshrrev_b32 v2, 2, v0
    v_lshrrev_b32 v3, 4, v0
    v_xor_b32 v2, v2, v3
    v_and_b32 v2, 1, v2
    v_lshlrev_b32 v2, 6, v2
    v_and_b32 v3, 3, v0
    v_lshl_add_u32 v2, v3, 4, v2
    v_lshrrev_b32 v3, 3, v0
    v_lshl_add_u32 v7, v3, 10, v2
    v_lshrrev_b32 v2, 5, v0
    v_bfe_u32 v3, v0, 2, 2
    v_lshl_add_u32 v2, v2, 3, v3
    v_lshlrev_b32 v2, 7, v2
    v_lshrrev_b32 v3, 1, v3
    v_xor_b32 v3, s36, v3
    v_lshl_add_u32 v2, v3, 6, v2
    v_bfe_u32 v3, v0, 4, 1
    v_lshl_add_u32 v2, v3, 5, v2
    v_and_b32 v3, 3, v0
    v_lshl_add_u32 v2, v3, 3, v2
    v_add_u32 v10, s42, v2
    v_xor_b32 v11, 64, v10
    s_lshl_b32 s21, s37, 5
    s_lshl_b32 s22, s17, 2
    s_add_u32 s21, s21, s22
    v_bfe_u32 v2, v0, 2, 1
    v_lshlrev_b32 v2, 4, v2
    v_and_b32 v3, 3, v0
    v_add3_u32 v2, v2, v3, s21
    v_lshlrev_b32 v2, 7, v2
    v_add_u32 v2, 10747904, v2
    s_and_b32 s21, s37, 1
    s_lshl_b32 s21, s21, 9
    s_lshr_b32 s23, s37, 1
    s_lshl_b32 s34, s23, 2
    s_add_u32 s21, s21, s34
    v_and_b32 v4, 7, v0
    v_lshlrev_b32 v4, 6, v4
    v_add_u32 v4, s21, v4
    v_lshlrev_b32 v4, 7, v4
    v_add_u32 v4, 10485760, v4
    v_cmp_le_u32 vcc, 8, v0
    s_nop 1
    v_cndmask_b32 v2, v2, v4, vcc
    v_add_u32 v3, s22, v3
    v_lshrrev_b32 v4, 1, v3
    v_and_b32 v3, 1, v3
    v_lshl_add_u32 v4, v3, 3, v4
    s_lshl_b32 s23, s23, 4
    v_add_u32 v4, s23, v4
    v_and_b32 v3, 1, v4
    v_lshlrev_b32 v3, 3, v3
    v_bfe_u32 v5, v4, 3, 3
    v_add_u32 v3, v3, v5
    v_lshlrev_b32 v3, 2, v3
    v_bfe_u32 v5, v4, 1, 2
    v_lshl_add_u32 v3, v5, 8, v3
    v_lshrrev_b32 v5, 6, v4
    v_lshl_add_u32 v3, v5, 6, v3
    v_lshlrev_b32 v3, 7, v3
    v_add_u32 v3, 10485760, v3
    v_cmp_le_u32 vcc, 16, v0
    s_nop 1
    v_cndmask_b32 v2, v2, v3, vcc
    s_waitcnt vmcnt(0) lgkmcnt(0)
L_epg:
    v_cmp_ne_u32 vcc, 0, v154
    s_cbranch_vccnz L_epokg
    v_mov_b32 v3, 0
    buffer_load_dwordx2 v[154:155], v3, s[12:15], 0 offen sc1
    s_sub_u32 s20, s20, 1
    s_waitcnt vmcnt(0)
    s_cbranch_scc0 L_epg
    s_mov_b32 s20, 0
L_epokg:
    s_mov_b64 exec, 0xfffff
L_gm_pollF:
    buffer_load_dwordx2 v[4:5], v2, s[8:11], 0 offen sc1
    s_waitcnt vmcnt(0)
    v_cmp_ne_u64 vcc, v[4:5], v[154:155]
    s_cbranch_vccz L_gm_okF
    s_sleep 8
    s_sub_u32 s20, s20, 1
    s_cbranch_scc0 L_gm_pollF
    s_mov_b32 s20, 0
L_gm_okF:
    s_mov_b64 exec, -1
    s_lshl_b32 s21, s37, 8
    s_add_u32 s21, s21, 8388608
    v_and_b32 v2, 31, v0
    v_lshlrev_b32 v2, 2, v2
    s_lshl_b32 s22, s35, 7
    v_xor_b32 v2, s22, v2
    v_xor_b32 v3, 128, v2
    buffer_load_dword v14, v2, s[8:11], s21 offen sc1
    buffer_load_dword v15, v3, s[8:11], s21 offen sc1
    s_add_u32 m0, s42, 0
    s_add_u32 s41, s40, 8192
    buffer_load_dwordx4 v7, s[24:27], s40 offen lds
    s_add_u32 m0, s42, 1024
    s_add_u32 s40, s40, 16384
    buffer_load_dwordx4 v7, s[24:27], s41 offen lds
    buffer_load_dwordx4 v[48:51], v12, s[8:11], s39 offen sc1
    buffer_load_dwordx4 v[52:55], v13, s[8:11], s39 offen sc1
    s_add_u32 s39, s39, 1024
    s_add_u32 m0, s42, 2048
    s_add_u32 s41, s40, 8192
    buffer_load_dwordx4 v7, s[24:27], s40 offen lds
    s_add_u32 m0, s42, 3072
    s_add_u32 s40, s40, 16384
    buffer_load_dwordx4 v7, s[24:27], s41 offen lds
    buffer_load_dwordx4 v[56:59], v12, s[8:11], s39 offen sc1
    buffer_load_dwordx4 v[60:63], v13, s[8:11], s39 offen sc1
    s_add_u32 s39, s39, 1024
    s_add_u32 m0, s42, 4096
    s_add_u32 s41, s40, 8192
    buffer_load_dwordx4 v7, s[24:27], s40 offen lds
    s_add_u32 m0, s42, 5120
    s_add_u32 s40, s40, 16384
    buffer_load_dwordx4 v7, s[24:27], s41 offen lds
    buffer_load_dwordx4 v[64:67], v12, s[8:11], s39 offen sc1
    buffer_load_dwordx4 v[68:71], v13, s[8:11], s39 offen sc1
    s_add_u32 s39, s39, 1024
    s_add_u32 m0, s42, 6144
    s_add_u32 s41, s40, 8192
    buffer_load_dwordx4 v7, s[24:27], s40 offen lds
    s_add_u32 m0, s42, 7168
    s_add_u32 s40, s40, 16384
    buffer_load_dwordx4 v7, s[24:27], s41 offen lds
    buffer_load_dwordx4 v[72:75], v12, s[8:11], s39 offen sc1
    buffer_load_dwordx4 v[76:79], v13, s[8:11], s39 offen sc1
    s_add_u32 s39, s39, 1024
    v_mov_b32 v24, 0
    v_mov_b32 v25, 0
    v_mov_b32 v26, 0
    v_mov_b32 v27, 0
    s_nop 1
    v_mfma_f32_32x32x16_bf16 v[80:95], v[24:27], v[24:27], 0
    v_mfma_f32_32x32x16_bf16 v[96:111], v[24:27], v[24:27], 0
    v_mfma_f32_32x32x16_bf16 v[112:127], v[24:27], v[24:27], 0
    v_mfma_f32_32x32x16_bf16 v[128:143], v[24:27], v[24:27], 0
    s_mov_b32 s32, 0
    s_waitcnt vmcnt(12)
    ds_read_b64_tr_b16 v[16:17], v10 offset:0
    ds_read_b64_tr_b16 v[18:19], v10 offset:512
    ds_read_b64_tr_b16 v[20:21], v11 offset:0
    ds_read_b64_tr_b16 v[22:23], v11 offset:512
.p2align 6
L_gm_f2loop:
    s_waitcnt vmcnt(8)
    ds_read_b64_tr_b16 v[24:25], v10 offset:2048
    ds_read_b64_tr_b16 v[26:27], v10 offset:2560
    ds_read_b64_tr_b16 v[28:29], v11 offset:2048
    ds_read_b64_tr_b16 v[30:31], v11 offset:2560
    s_waitcnt lgkmcnt(4)
    v_mfma_f32_32x32x16_bf16 v[80:95], v[16:19], v[48:51], v[80:95]
    v_mfma_f32_32x32x16_bf16 v[96:111], v[16:19], v[52:55], v[96:111]
    v_mfma_f32_32x32x16_bf16 v[112:127], v[20:23], v[48:51], v[112:127]
    v_mfma_f32_32x32x16_bf16 v[128:143], v[20:23], v[52:55], v[128:143]
    s_add_u32 m0, s42, 0
    s_add_u32 s41, s40, 8192
    buffer_load_dwordx4 v7, s[24:27], s40 offen lds
    s_add_u32 m0, s42, 1024
    s_add_u32 s40, s40, 16384
    buffer_load_dwordx4 v7, s[24:27], s41 offen lds
    buffer_load_dwordx4 v[48:51], v12, s[8:11], s39 offen sc1
    buffer_load_dwordx4 v[52:55], v13, s[8:11], s39 offen sc1
    s_add_u32 s39, s39, 1024
    s_waitcnt vmcnt(8)
    ds_read_b64_tr_b16 v[16:17], v10 offset:4096
    ds_read_b64_tr_b16 v[18:19], v10 offset:4608
    ds_read_b64_tr_b16 v[20:21], v11 offset:4096
    ds_read_b64_tr_b16 v[22:23], v11 offset:4608
    s_waitcnt lgkmcnt(4)
    v_mfma_f32_32x32x16_bf16 v[80:95], v[24:27], v[56:59], v[80:95]
    v_mfma_f32_32x32x16_bf16 v[96:111], v[24:27], v[60:63], v[96:111]
    v_mfma_f32_32x32x16_bf16 v[112:127], v[28:31], v[56:59], v[112:127]
    v_mfma_f32_32x32x16_bf16 v[128:143], v[28:31], v[60:63], v[128:143]
    s_add_u32 m0, s42, 2048
    s_add_u32 s41, s40, 8192
    buffer_load_dwordx4 v7, s[24:27], s40 offen lds
    s_add_u32 m0, s42, 3072
    s_add_u32 s40, s40, 16384
    buffer_load_dwordx4 v7, s[24:27], s41 offen lds
    buffer_load_dwordx4 v[56:59], v12, s[8:11], s39 offen sc1
    buffer_load_dwordx4 v[60:63], v13, s[8:11], s39 offen sc1
    s_add_u32 s39, s39, 1024
    s_waitcnt vmcnt(8)
    ds_read_b64_tr_b16 v[24:25], v10 offset:6144
    ds_read_b64_tr_b16 v[26:27], v10 offset:6656
    ds_read_b64_tr_b16 v[28:29], v11 offset:6144
    ds_read_b64_tr_b16 v[30:31], v11 offset:6656
    s_waitcnt lgkmcnt(4)
    v_mfma_f32_32x32x16_bf16 v[80:95], v[16:19], v[64:67], v[80:95]
    v_mfma_f32_32x32x16_bf16 v[96:111], v[16:19], v[68:71], v[96:111]
    v_mfma_f32_32x32x16_bf16 v[112:127], v[20:23], v[64:67], v[112:127]
    v_mfma_f32_32x32x16_bf16 v[128:143], v[20:23], v[68:71], v[128:143]
    s_add_u32 m0, s42, 4096
    s_add_u32 s41, s40, 8192
    buffer_load_dwordx4 v7, s[24:27], s40 offen lds
    s_add_u32 m0, s42, 5120
    s_add_u32 s40, s40, 16384
    buffer_load_dwordx4 v7, s[24:27], s41 offen lds
    buffer_load_dwordx4 v[64:67], v12, s[8:11], s39 offen sc1
    buffer_load_dwordx4 v[68:71], v13, s[8:11], s39 offen sc1
    s_add_u32 s39, s39, 1024
    s_waitcnt vmcnt(8)
    ds_read_b64_tr_b16 v[16:17], v10 offset:0
    ds_read_b64_tr_b16 v[18:19], v10 offset:512
    ds_read_b64_tr_b16 v[20:21], v11 offset:0
    ds_read_b64_tr_b16 v[22:23], v11 offset:512
    s_waitcnt lgkmcnt(4)
    v_mfma_f32_32x32x16_bf16 v[80:95], v[24:27], v[72:75], v[80:95]
    v_mfma_f32_32x32x16_bf16 v[96:111], v[24:27], v[76:79], v[96:111]
    v_mfma_f32_32x32x16_bf16 v[112:127], v[28:31], v[72:75], v[112:127]
    v_mfma_f32_32x32x16_bf16 v[128:143], v[28:31], v[76:79], v[128:143]
    s_add_u32 m0, s42, 6144
    s_add_u32 s41, s40, 8192
    buffer_load_dwordx4 v7, s[24:27], s40 offen lds
    s_add_u32 m0, s42, 7168
    s_add_u32 s40, s40, 16384
    buffer_load_dwordx4 v7, s[24:27], s41 offen lds
    buffer_load_dwordx4 v[72:75], v12, s[8:11], s39 offen sc1
    buffer_load_dwordx4 v[76:79], v13, s[8:11], s39 offen sc1
    s_add_u32 s39, s39, 1024
    s_add_u32 s32, s32, 1
    s_cmp_lt_u32 s32, 6
    s_cbranch_scc1 L_gm_f2loop
    s_mov_b32 s24, s44
    s_mov_b32 s25, s45
    s_mov_b32 s26, 524288
    s_lshl_b32 s40, s17, 16
    s_lshl_b32 s23, s38, 7
    s_add_u32 s40, s40, s23
    s_waitcnt vmcnt(8)
    ds_read_b64_tr_b16 v[24:25], v10 offset:2048
    ds_read_b64_tr_b16 v[26:27], v10 offset:2560
    ds_read_b64_tr_b16 v[28:29], v11 offset:2048
    ds_read_b64_tr_b16 v[30:31], v11 offset:2560
    s_waitcnt lgkmcnt(4)
    v_mfma_f32_32x32x16_bf16 v[80:95], v[16:19], v[48:51], v[80:95]
    v_mfma_f32_32x32x16_bf16 v[96:111], v[16:19], v[52:55], v[96:111]
    v_mfma_f32_32x32x16_bf16 v[112:127], v[20:23], v[48:51], v[112:127]
    v_mfma_f32_32x32x16_bf16 v[128:143], v[20:23], v[52:55], v[128:143]
    s_add_u32 m0, s42, 0
    s_add_u32 s41, s40, 8192
    buffer_load_dwordx4 v7, s[24:27], s40 offen lds
    s_add_u32 m0, s42, 1024
    s_add_u32 s40, s40, 16384
    buffer_load_dwordx4 v7, s[24:27], s41 offen lds
    s_waitcnt vmcnt(6)
    ds_read_b64_tr_b16 v[16:17], v10 offset:4096
    ds_read_b64_tr_b16 v[18:19], v10 offset:4608
    ds_read_b64_tr_b16 v[20:21], v11 offset:4096
    ds_read_b64_tr_b16 v[22:23], v11 offset:4608
    s_waitcnt lgkmcnt(4)
    v_mfma_f32_32x32x16_bf16 v[80:95], v[24:27], v[56:59], v[80:95]
    v_mfma_f32_32x32x16_bf16 v[96:111], v[24:27], v[60:63], v[96:111]
    v_mfma_f32_32x32x16_bf16 v[112:127], v[28:31], v[56:59], v[112:127]
    v_mfma_f32_32x32x16_bf16 v[128:143], v[28:31], v[60:63], v[128:143]
    s_add_u32 m0, s42, 2048
    s_add_u32 s41, s40, 8192
    buffer_load_dwordx4 v7, s[24:27], s40 offen lds
    s_add_u32 m0, s42, 3072
    s_add_u32 s40, s40, 16384
    buffer_load_dwordx4 v7, s[24:27], s41 offen lds
    s_waitcnt vmcnt(4)
    ds_read_b64_tr_b16 v[24:25], v10 offset:6144
    ds_read_b64_tr_b16 v[26:27], v10 offset:6656
    ds_read_b64_tr_b16 v[28:29], v11 offset:6144
    ds_read_b64_tr_b16 v[30:31], v11 offset:6656
    s_waitcnt lgkmcnt(4)
    v_mfma_f32_32x32x16_bf16 v[80:95], v[16:19], v[64:67], v[80:95]
    v_mfma_f32_32x32x16_bf16 v[96:111], v[16:19], v[68:71], v[96:111]
    v_mfma_f32_32x32x16_bf16 v[112:127], v[20:23], v[64:67], v[112:127]
    v_mfma_f32_32x32x16_bf16 v[128:143], v[20:23], v[68:71], v[128:143]
    s_add_u32 m0, s42, 4096
    s_add_u32 s41, s40, 8192
    buffer_load_dwordx4 v7, s[24:27], s40 offen lds
    s_add_u32 m0, s42, 5120
    s_add_u32 s40, s40, 16384
    buffer_load_dwordx4 v7, s[24:27], s41 offen lds
    s_waitcnt lgkmcnt(0)
    v_mfma_f32_32x32x16_bf16 v[80:95], v[24:27], v[72:75], v[80:95]
    v_mfma_f32_32x32x16_bf16 v[96:111], v[24:27], v[76:79], v[96:111]
    v_mfma_f32_32x32x16_bf16 v[112:127], v[28:31], v[72:75], v[112:127]
    v_mfma_f32_32x32x16_bf16 v[128:143], v[28:31], v[76:79], v[128:143]
    s_add_u32 m0, s42, 6144
    s_add_u32 s41, s40, 8192
    buffer_load_dwordx4 v7, s[24:27], s40 offen lds
    s_add_u32 m0, s42, 7168
    s_add_u32 s40, s40, 16384
    buffer_load_dwordx4 v7, s[24:27], s41 offen lds
    s_setprio 2
    v_sub_f32 v14, 1.0, v14
    v_sub_f32 v15, 1.0, v15
    s_lshl_b32 s39, s37, 16
    s_lshl_b32 s21, s17, 12
    s_add_u32 s39, s39, s21
    s_add_u32 s39, s39, 6291456
    s_lshl_b32 s21, s35, 15
    v_add_u32 v12, s21, v1
    v_xor_b32 v13, 0x8000, v12
    v_and_b32 v2, 3, v0
    v_bfe_u32 v3, v0, 2, 1
    v_lshlrev_b32 v2, 10, v2
    v_lshl_add_u32 v5, v3, 15, v2
    s_add_u32 s40, s40, 196608
    s_mov_b32 s32, 0
    v_pk_mul_f32 v[80:81], v[80:81], v[14:15] op_sel:[0,0] op_sel_hi:[1,0]
    v_pk_mul_f32 v[82:83], v[82:83], v[14:15] op_sel:[0,0] op_sel_hi:[1,0]
    v_pk_mul_f32 v[84:85], v[84:85], v[14:15] op_sel:[0,0] op_sel_hi:[1,0]
    v_pk_mul_f32 v[86:87], v[86:87], v[14:15] op_sel:[0,0] op_sel_hi:[1,0]
    v_pk_mul_f32 v[88:89], v[88:89], v[14:15] op_sel:[0,0] op_sel_hi:[1,0]
    v_pk_mul_f32 v[90:91], v[90:91], v[14:15] op_sel:[0,0] op_sel_hi:[1,0]
    v_pk_mul_f32 v[92:93], v[92:93], v[14:15] op_sel:[0,0] op_sel_hi:[1,0]
    v_pk_mul_f32 v[94:95], v[94:95], v[14:15] op_sel:[0,0] op_sel_hi:[1,0]
    v_pk_mul_f32 v[96:97], v[96:97], v[14:15] op_sel:[0,1] op_sel_hi:[1,1]
    v_pk_mul_f32 v[98:99], v[98:99], v[14:15] op_sel:[0,1] op_sel_hi:[1,1]
    v_pk_mul_f32 v[100:101], v[100:101], v[14:15] op_sel:[0,1] op_sel_hi:[1,1]
    v_pk_mul_f32 v[102:103], v[102:103], v[14:15] op_sel:[0,1] op_sel_hi:[1,1]
    v_pk_mul_f32 v[104:105], v[104:105], v[14:15] op_sel:[0,1] op_sel_hi:[1,1]
    v_pk_mul_f32 v[106:107], v[106:107], v[14:15] op_sel:[0,1] op_sel_hi:[1,1]
    v_pk_mul_f32 v[108:109], v[108:109], v[14:15] op_sel:[0,1] op_sel_hi:[1,1]
    v_pk_mul_f32 v[110:111], v[110:111], v[14:15] op_sel:[0,1] op_sel_hi:[1,1]
    v_pk_mul_f32 v[112:113], v[112:113], v[14:15] op_sel:[0,0] op_sel_hi:[1,0]
    v_pk_mul_f32 v[114:115], v[114:115], v[14:15] op_sel:[0,0] op_sel_hi:[1,0]
    v_pk_mul_f32 v[116:117], v[116:117], v[14:15] op_sel:[0,0] op_sel_hi:[1,0]
    v_pk_mul_f32 v[118:119], v[118:119], v[14:15] op_sel:[0,0] op_sel_hi:[1,0]
    v_pk_mul_f32 v[120:121], v[120:121], v[14:15] op_sel:[0,0] op_sel_hi:[1,0]
    v_pk_mul_f32 v[122:123], v[122:123], v[14:15] op_sel:[0,0] op_sel_hi:[1,0]
    v_pk_mul_f32 v[124:125], v[124:125], v[14:15] op_sel:[0,0] op_sel_hi:[1,0]
    v_pk_mul_f32 v[126:127], v[126:127], v[14:15] op_sel:[0,0] op_sel_hi:[1,0]
    v_pk_mul_f32 v[128:129], v[128:129], v[14:15] op_sel:[0,1] op_sel_hi:[1,1]
    v_pk_mul_f32 v[130:131], v[130:131], v[14:15] op_sel:[0,1] op_sel_hi:[1,1]
    v_pk_mul_f32 v[132:133], v[132:133], v[14:15] op_sel:[0,1] op_sel_hi:[1,1]
    v_pk_mul_f32 v[134:135], v[134:135], v[14:15] op_sel:[0,1] op_sel_hi:[1,1]
    v_pk_mul_f32 v[136:137], v[136:137], v[14:15] op_sel:[0,1] op_sel_hi:[1,1]
    v_pk_mul_f32 v[138:139], v[138:139], v[14:15] op_sel:[0,1] op_sel_hi:[1,1]
    v_pk_mul_f32 v[140:141], v[140:141], v[14:15] op_sel:[0,1] op_sel_hi:[1,1]
    v_pk_mul_f32 v[142:143], v[142:143], v[14:15] op_sel:[0,1] op_sel_hi:[1,1]
L_gm_ph:
    s_mov_b64 exec, 0xff
L_gm_pollO:
    buffer_load_dword v3, v5, s[8:11], s39 offen offset:1020 sc1
    s_waitcnt vmcnt(0)
    v_cmp_eq_u32 vcc, -1, v3
    s_cbranch_vccz L_gm_loadO
    s_sleep 12
    s_sub_u32 s20, s20, 1
    s_cbranch_scc0 L_gm_pollO
    s_mov_b32 s20, 0
L_gm_loadO:
    s_mov_b64 exec, -1
    buffer_load_dwordx4 v[48:51], v12, s[8:11], s39 offen offset:0 sc1
    buffer_load_dwordx4 v[52:55], v13, s[8:11], s39 offen offset:0 sc1
    buffer_load_dwordx4 v[56:59], v12, s[8:11], s39 offen offset:1024 sc1
    buffer_load_dwordx4 v[60:63], v13, s[8:11], s39 offen offset:1024 sc1
    buffer_load_dwordx4 v[64:67], v12, s[8:11], s39 offen offset:2048 sc1
    buffer_load_dwordx4 v[68:71], v13, s[8:11], s39 offen offset:2048 sc1
    buffer_load_dwordx4 v[72:75], v12, s[8:11], s39 offen offset:3072 sc1
    buffer_load_dwordx4 v[76:79], v13, s[8:11], s39 offen offset:3072 sc1
    ds_read_b64_tr_b16 v[16:17], v10 offset:0
    ds_read_b64_tr_b16 v[18:19], v10 offset:512
    ds_read_b64_tr_b16 v[20:21], v11 offset:0
    ds_read_b64_tr_b16 v[22:23], v11 offset:512
    s_waitcnt vmcnt(0)
    v_max3_u32 v3, v48, v49, v50
    v_max3_u32 v3, v3, v51, v52
    v_max3_u32 v3, v3, v53, v54
    v_max3_u32 v3, v3, v55, v56
    v_max3_u32 v3, v3, v57, v58
    v_max3_u32 v3, v3, v59, v60
    v_max3_u32 v3, v3, v61, v62
    v_max3_u32 v3, v3, v63, v64
    v_max3_u32 v3, v3, v65, v66
    v_max3_u32 v3, v3, v67, v68
    v_max3_u32 v3, v3, v69, v70
    v_max3_u32 v3, v3, v71, v72
    v_max3_u32 v3, v3, v73, v74
    v_max3_u32 v3, v3, v75, v76
    v_max3_u32 v3, v3, v77, v78
    v_max_u32 v3, v3, v79
    v_cmp_eq_u32 vcc, -1, v3
    s_cbranch_vccz L_gm_okO
    s_sub_u32 s20, s20, 1
    s_cbranch_scc0 L_gm_loadO
    s_mov_b32 s20, 0
L_gm_okO:
    ds_read_b64_tr_b16 v[24:25], v10 offset:2048
    ds_read_b64_tr_b16 v[26:27], v10 offset:2560
    ds_read_b64_tr_b16 v[28:29], v11 offset:2048
    ds_read_b64_tr_b16 v[30:31], v11 offset:2560
    s_waitcnt lgkmcnt(4)
    v_mfma_f32_32x32x16_bf16 v[80:95], v[16:19], v[48:51], v[80:95]
    v_mfma_f32_32x32x16_bf16 v[96:111], v[16:19], v[52:55], v[96:111]
    v_mfma_f32_32x32x16_bf16 v[112:127], v[20:23], v[48:51], v[112:127]
    v_mfma_f32_32x32x16_bf16 v[128:143], v[20:23], v[52:55], v[128:143]
    ds_read_b64_tr_b16 v[16:17], v10 offset:4096
    ds_read_b64_tr_b16 v[18:19], v10 offset:4608
    ds_read_b64_tr_b16 v[20:21], v11 offset:4096
    ds_read_b64_tr_b16 v[22:23], v11 offset:4608
    s_waitcnt lgkmcnt(4)
    v_mfma_f32_32x32x16_bf16 v[80:95], v[24:27], v[56:59], v[80:95]
    v_mfma_f32_32x32x16_bf16 v[96:111], v[24:27], v[60:63], v[96:111]
    v_mfma_f32_32x32x16_bf16 v[112:127], v[28:31], v[56:59], v[112:127]
    v_mfma_f32_32x32x16_bf16 v[128:143], v[28:31], v[60:63], v[128:143]
    ds_read_b64_tr_b16 v[24:25], v10 offset:6144
    ds_read_b64_tr_b16 v[26:27], v10 offset:6656
    ds_read_b64_tr_b16 v[28:29], v11 offset:6144
    ds_read_b64_tr_b16 v[30:31], v11 offset:6656
    s_waitcnt lgkmcnt(4)
    v_mfma_f32_32x32x16_bf16 v[80:95], v[16:19], v[64:67], v[80:95]
    v_mfma_f32_32x32x16_bf16 v[96:111], v[16:19], v[68:71], v[96:111]
    v_mfma_f32_32x32x16_bf16 v[112:127], v[20:23], v[64:67], v[112:127]
    v_mfma_f32_32x32x16_bf16 v[128:143], v[20:23], v[68:71], v[128:143]
    s_waitcnt lgkmcnt(0)
    v_mfma_f32_32x32x16_bf16 v[80:95], v[24:27], v[72:75], v[80:95]
    v_mfma_f32_32x32x16_bf16 v[96:111], v[24:27], v[76:79], v[96:111]
    v_mfma_f32_32x32x16_bf16 v[112:127], v[28:31], v[72:75], v[112:127]
    v_mfma_f32_32x32x16_bf16 v[128:143], v[28:31], v[76:79], v[128:143]
    s_cmp_eq_u32 s32, 1
    s_cbranch_scc1 L_gm_red
    s_add_u32 m0, s42, 0
    s_add_u32 s41, s40, 8192
    buffer_load_dwordx4 v7, s[24:27], s40 offen lds
    s_add_u32 m0, s42, 1024
    s_add_u32 s40, s40, 16384
    buffer_load_dwordx4 v7, s[24:27], s41 offen lds
    s_add_u32 m0, s42, 2048
    s_add_u32 s41, s40, 8192
    buffer_load_dwordx4 v7, s[24:27], s40 offen lds
    s_add_u32 m0, s42, 3072
    s_add_u32 s40, s40, 16384
    buffer_load_dwordx4 v7, s[24:27], s41 offen lds
    s_add_u32 m0, s42, 4096
    s_add_u32 s41, s40, 8192
    buffer_load_dwordx4 v7, s[24:27], s40 offen lds
    s_add_u32 m0, s42, 5120
    s_add_u32 s40, s40, 16384
    buffer_load_dwordx4 v7, s[24:27], s41 offen lds
    s_add_u32 m0, s42, 6144
    s_add_u32 s41, s40, 8192
    buffer_load_dwordx4 v7, s[24:27], s40 offen lds
    s_add_u32 m0, s42, 7168
    s_add_u32 s40, s40, 16384
    buffer_load_dwordx4 v7, s[24:27], s41 offen lds
    s_add_u32 s39, s39, 16384
    s_mov_b32 s32, 1
    s_branch L_gm_ph
L_gm_red:
    s_nop 7
    v_add_u32 v2, s42, v1
    s_nop 3
    ds_write_b128 v2, v[96:99] offset:0
    ds_write_b128 v2, v[100:103] offset:1024
    ds_write_b128 v2, v[104:107] offset:2048
    ds_write_b128 v2, v[108:111] offset:3072
    ds_write_b128 v2, v[112:115] offset:4096
    ds_write_b128 v2, v[116:119] offset:5120
    ds_write_b128 v2, v[120:123] offset:6144
    ds_write_b128 v2, v[124:127] offset:7168
    ds_write_b128 v2, v[128:131] offset:8192
    ds_write_b128 v2, v[132:135] offset:9216
    ds_write_b128 v2, v[136:139] offset:10240
    ds_write_b128 v2, v[140:143] offset:11264
    s_waitcnt lgkmcnt(0)
    v_mov_b32 v3, 147464
    v_mov_b32 v4, 1
    s_mov_b64 exec, 1
    ds_add_u32 v3, v4
    s_mov_b64 exec, -1
L_gsgm:
    ds_read_b32 v4, v3
    s_sub_u32 s20, s20, 1
    s_cselect_b32 s22, 4, 0
    s_waitcnt lgkmcnt(0)
    v_readfirstlane_b32 s21, v4
    s_nop 0
    s_add_u32 s21, s21, s22
    s_cmp_lt_u32 s21, 4
    s_cbranch_scc1 L_gsgm
    s_xor_b32 s21, s17, 1
    s_mul_i32 s21, s21, 12288
    s_add_u32 s21, s21, 98304
    v_add_u32 v3, s21, v1
    ds_read_b128 v[96:99], v3 offset:0
    ds_read_b128 v[100:103], v3 offset:1024
    ds_read_b128 v[104:107], v3 offset:2048
    ds_read_b128 v[108:111], v3 offset:3072
    s_xor_b32 s21, s17, 2
    s_mul_i32 s21, s21, 12288
    s_add_u32 s21, s21, 98304
    v_add_u32 v3, s21, v1
    ds_read_b128 v[112:115], v3 offset:4096
    ds_read_b128 v[116:119], v3 offset:5120
    ds_read_b128 v[120:123], v3 offset:6144
    ds_read_b128 v[124:127], v3 offset:7168
    s_xor_b32 s21, s17, 3
    s_mul_i32 s21, s21, 12288
    s_add_u32 s21, s21, 98304
    v_add_u32 v3, s21, v1
    ds_read_b128 v[128:131], v3 offset:8192
    ds_read_b128 v[132:135], v3 offset:9216
    ds_read_b128 v[136:139], v3 offset:10240
    ds_read_b128 v[140:143], v3 offset:11264
    s_lshl_b32 s21, s37, 1
    s_add_u32 s21, s21, s35
    s_lshl_b32 s21, s21, 15
    s_lshl_b32 s22, s38, 7
    s_add_u32 s21, s21, s22
    s_lshl_b32 s22, s36, 6
    s_add_u32 s21, s21, s22
    v_and_b32 v2, 31, v0
    v_lshlrev_b32 v2, 10, v2
    v_lshrrev_b32 v4, 5, v0
    v_lshl_add_u32 v2, v4, 4, v2
    s_waitcnt lgkmcnt(8)
    v_pk_add_f32 v[80:81], v[80:81], v[96:97]
    v_pk_add_f32 v[82:83], v[82:83], v[98:99]
    v_pk_add_f32 v[84:85], v[84:85], v[100:101]
    v_pk_add_f32 v[86:87], v[86:87], v[102:103]
    v_pk_add_f32 v[88:89], v[88:89], v[104:105]
    v_pk_add_f32 v[90:91], v[90:91], v[106:107]
    v_pk_add_f32 v[92:93], v[92:93], v[108:109]
    v_pk_add_f32 v[94:95], v[94:95], v[110:111]
    s_waitcnt lgkmcnt(0)
    v_pk_add_f32 v[112:113], v[112:113], v[128:129]
    v_pk_add_f32 v[114:115], v[114:115], v[130:131]
    v_pk_add_f32 v[116:117], v[116:117], v[132:133]
    v_pk_add_f32 v[118:119], v[118:119], v[134:135]
    v_pk_add_f32 v[120:121], v[120:121], v[136:137]
    v_pk_add_f32 v[122:123], v[122:123], v[138:139]
    v_pk_add_f32 v[124:125], v[124:125], v[140:141]
    v_pk_add_f32 v[126:127], v[126:127], v[142:143]
    v_pk_add_f32 v[80:81], v[80:81], v[112:113]
    v_pk_add_f32 v[82:83], v[82:83], v[114:115]
    v_pk_add_f32 v[84:85], v[84:85], v[116:117]
    v_pk_add_f32 v[86:87], v[86:87], v[118:119]
    v_pk_add_f32 v[88:89], v[88:89], v[120:121]
    v_pk_add_f32 v[90:91], v[90:91], v[122:123]
    v_pk_add_f32 v[92:93], v[92:93], v[124:125]
    v_pk_add_f32 v[94:95], v[94:95], v[126:127]
    v_cvt_pk_bf16_f32 v16, v80, v81
    v_cvt_pk_bf16_f32 v17, v82, v83
    v_cvt_pk_bf16_f32 v18, v84, v85
    v_cvt_pk_bf16_f32 v19, v86, v87
    v_cvt_pk_bf16_f32 v20, v88, v89
    v_cvt_pk_bf16_f32 v21, v90, v91
    v_cvt_pk_bf16_f32 v22, v92, v93
    v_cvt_pk_bf16_f32 v23, v94, v95
    v_permlane32_swap_b32 v16, v18
    v_permlane32_swap_b32 v17, v19
    v_permlane32_swap_b32 v20, v22
    v_permlane32_swap_b32 v21, v23
    buffer_store_dwordx4 v[16:19], v2, s[28:31], s21 offen
    buffer_store_dwordx4 v[20:23], v2, s[28:31], s21 offen offset:32
    s_endpgm
L_comp:
    v_and_b32 v2, 15, v0
    v_bfe_u32 v4, v0, 2, 2
    v_and_b32 v5, 3, v0
    v_lshrrev_b32 v6, 1, v2
    v_xor_b32 v6, v3, v6
    v_lshlrev_b32 v6, 4, v6
    v_lshl_add_u32 v6, v2, 7, v6
    s_lshl_b32 s21, s17, 12
    v_add_u32 v10, s21, v6
    v_xor_b32 v11, 64, v10
    s_mov_b32 s65, 0
    v_lshl_add_u32 v7, v3, 3, v4
    v_and_b32 v8, 1, v3
    s_waitcnt lgkmcnt(0)
    s_cmp_ge_u32 s16, 4
    s_cbranch_scc1 L_ffn
    v_mul_u32_u24 v7, 192, v7
    v_lshl_add_u32 v7, v5, 3, v7
    v_add_u32 v7, 131072, v7
    v_lshlrev_b32 v8, 5, v8
    v_add_u32 v12, v7, v8
    v_sub_u32 v13, v7, v8
    s_and_b32 s21, s2, 7
    s_lshl_b32 s28, s21, 1
    s_bfe_u32 s21, s2, 0x10003
    s_add_u32 s28, s28, s21
    s_add_u32 s28, s28, 0
    s_bfe_u32 s29, s2, 0x40004
    s_mov_b32 s24, s8
    s_mov_b32 s25, s9
    s_mov_b32 s26, 20971520
    s_mov_b32 s27, 0x00020000
    s_mov_b32 s32, 0x0000ffff
    s_mov_b32 s33, 0x0000ffff
    s_lshl_b32 s21, s28, 16
    s_lshl_b32 s22, s29, 12
    s_add_u32 s34, s21, s22
    s_lshl_b32 s22, s17, 14
    s_add_u32 s30, s21, s22
    s_add_u32 s30, s30, 2097152
    s_mov_b32 s38, 0
    s_mov_b32 s39, 147456
    s_mov_b32 s42, 99
    s_lshl_b32 s43, s18, 2
    s_add_u32 s43, s43, s17
    s_lshl_b32 s43, s43, 4
    s_add_u32 s43, s43, s19
    s_lshl_b32 s43, s43, 7
    s_add_u32 s43, s43, 10747904
    s_mul_i32 s35, s17, 12288
    s_add_u32 s35, s35, s38
    v_lshlrev_b32 v1, 4, v0
    v_add_u32 v2, 2097152, v1
    s_lshr_b32 s21, s28, 2
    s_lshl_b32 s21, s21, 6
    s_lshl_b32 s22, s17, 4
    s_add_u32 s23, s21, s22
    s_add_u32 s23, s23, 512
    v_add_u32 v156, s23, v0
    s_lshr_b32 s23, s28, 1
    s_lshl_b32 s23, s23, 6
    s_add_u32 s23, s23, s22
    s_sub_u32 s23, s23, 16
    v_add_u32 v3, s23, v0
    v_cmp_le_u32 vcc, 16, v0
    s_nop 1
    v_cndmask_b32 v156, v156, v3, vcc
    s_lshl_b32 s22, s29, 2
    s_add_u32 s23, s21, s22
    s_sub_u32 s23, s23, 32
    v_add_u32 v3, s23, v0
    v_cmp_le_u32 vcc, 32, v0
    s_nop 1
    v_cndmask_b32 v156, v156, v3, vcc
    s_lshl_b32 s23, s17, 8
    s_add_u32 s23, s23, s22
    v_and_b32 v3, 3, v0
    v_lshlrev_b32 v3, 6, v3
    v_add_u32 v3, s23, v3
    v_cmp_le_u32 vcc, 36, v0
    s_nop 1
    v_cndmask_b32 v156, v156, v3, vcc
    v_lshlrev_b32 v156, 7, v156
    v_add_u32 v156, 10485760, v156
    s_waitcnt vmcnt(0)
    v_mov_b32 v96, 0
    v_mov_b32 v97, 0
    v_mov_b32 v98, 0
    v_mov_b32 v99, 0
    v_mov_b32 v100, 0
    v_mov_b32 v101, 0
    v_mov_b32 v102, 0
    v_mov_b32 v103, 0
    v_mov_b32 v104, 0
    v_mov_b32 v105, 0
    v_mov_b32 v106, 0
    v_mov_b32 v107, 0
    v_mov_b32 v108, 0
    v_mov_b32 v109, 0
    v_mov_b32 v110, 0
    v_mov_b32 v111, 0
    v_mov_b32 v112, 0
    v_mov_b32 v113, 0
    v_mov_b32 v114, 0
    v_mov_b32 v115, 0
    v_mov_b32 v116, 0
    v_mov_b32 v117, 0
    v_mov_b32 v118, 0
    v_mov_b32 v119, 0
    v_mov_b32 v120, 0
    v_mov_b32 v121, 0
    v_mov_b32 v122, 0
    v_mov_b32 v123, 0
    v_mov_b32 v124, 0
    v_mov_b32 v125, 0
    v_mov_b32 v126, 0
    v_mov_b32 v127, 0
    v_mov_b32 v128, 0
    v_mov_b32 v129, 0
    v_mov_b32 v130, 0
    v_mov_b32 v131, 0
    v_mov_b32 v132, 0
    v_mov_b32 v133, 0
    v_mov_b32 v134, 0
    v_mov_b32 v135, 0
    v_mov_b32 v136, 0
    v_mov_b32 v137, 0
    v_mov_b32 v138, 0
    v_mov_b32 v139, 0
    v_mov_b32 v140, 0
    v_mov_b32 v141, 0
    v_mov_b32 v142, 0
    v_mov_b32 v143, 0
    s_barrier
    ds_read_b128 v[20:23], v10 offset:0
    ds_read_b128 v[24:27], v10 offset:2048
    ds_read_b64_tr_b16 v[28:29], v12 offset:0
    ds_read_b64_tr_b16 v[30:31], v12 offset:768
    ds_read_b64_tr_b16 v[32:33], v13 offset:32
    ds_read_b64_tr_b16 v[34:35], v13 offset:800
    ds_read_b64_tr_b16 v[36:37], v12 offset:64
    ds_read_b64_tr_b16 v[38:39], v12 offset:832
    ds_read_b64_tr_b16 v[40:41], v13 offset:96
    ds_read_b64_tr_b16 v[42:43], v13 offset:864
    ds_read_b64_tr_b16 v[44:45], v12 offset:128
    ds_read_b64_tr_b16 v[46:47], v12 offset:896
    ds_read_b64_tr_b16 v[48:49], v13 offset:160
    ds_read_b64_tr_b16 v[50:51], v13 offset:928
.p2align 6
L_qkv_loop:
    s_waitcnt lgkmcnt(0)
    v_mfma_f32_16x16x32_bf16 v[96:99], v[28:31], v[20:23], v[96:99]
    s_barrier
    v_mfma_f32_16x16x32_bf16 v[100:103], v[28:31], v[24:27], v[100:103]
    ds_read_b128 v[56:59], v11 offset:0
    ds_read_b128 v[60:63], v11 offset:2048
    v_mfma_f32_16x16x32_bf16 v[104:107], v[32:35], v[20:23], v[104:107]
    ds_read_b64_tr_b16 v[64:65], v12 offset:8192
    ds_read_b64_tr_b16 v[66:67], v12 offset:8960
    v_mfma_f32_16x16x32_bf16 v[108:111], v[32:35], v[24:27], v[108:111]
    ds_read_b64_tr_b16 v[68:69], v13 offset:8224
    ds_read_b64_tr_b16 v[70:71], v13 offset:8992
    v_mfma_f32_16x16x32_bf16 v[112:115], v[36:39], v[20:23], v[112:115]
    ds_read_b64_tr_b16 v[72:73], v12 offset:8256
    ds_read_b64_tr_b16 v[74:75], v12 offset:9024
    v_mfma_f32_16x16x32_bf16 v[116:119], v[36:39], v[24:27], v[116:119]
    ds_read_b64_tr_b16 v[76:77], v13 offset:8288
    ds_read_b64_tr_b16 v[78:79], v13 offset:9056
    v_mfma_f32_16x16x32_bf16 v[120:123], v[40:43], v[20:23], v[120:123]
    ds_read_b64_tr_b16 v[80:81], v12 offset:8320
    ds_read_b64_tr_b16 v[82:83], v12 offset:9088
    v_mfma_f32_16x16x32_bf16 v[124:127], v[40:43], v[24:27], v[124:127]
    ds_read_b64_tr_b16 v[84:85], v13 offset:8352
    ds_read_b64_tr_b16 v[86:87], v13 offset:9120
    v_mfma_f32_16x16x32_bf16 v[128:131], v[20:23], v[44:47], v[128:131]
    v_mfma_f32_16x16x32_bf16 v[132:135], v[24:27], v[44:47], v[132:135]
    v_mfma_f32_16x16x32_bf16 v[136:139], v[20:23], v[48:51], v[136:139]
    v_mfma_f32_16x16x32_bf16 v[140:143], v[24:27], v[48:51], v[140:143]
    s_waitcnt lgkmcnt(0)
    v_mfma_f32_16x16x32_bf16 v[96:99], v[64:67], v[56:59], v[96:99]
    s_barrier
    v_mfma_f32_16x16x32_bf16 v[100:103], v[64:67], v[60:63], v[100:103]
    ds_read_b128 v[20:23], v10 offset:16384
    ds_read_b128 v[24:27], v10 offset:18432
    v_mfma_f32_16x16x32_bf16 v[104:107], v[68:71], v[56:59], v[104:107]
    ds_read_b64_tr_b16 v[28:29], v12 offset:16384
    ds_read_b64_tr_b16 v[30:31], v12 offset:17152
    v_mfma_f32_16x16x32_bf16 v[108:111], v[68:71], v[60:63], v[108:111]
    ds_read_b64_tr_b16 v[32:33], v13 offset:16416
    ds_read_b64_tr_b16 v[34:35], v13 offset:17184
    v_mfma_f32_16x16x32_bf16 v[112:115], v[72:75], v[56:59], v[112:115]
    ds_read_b64_tr_b16 v[36:37], v12 offset:16448
    ds_read_b64_tr_b16 v[38:39], v12 offset:17216
    v_mfma_f32_16x16x32_bf16 v[116:119], v[72:75], v[60:63], v[116:119]
    ds_read_b64_tr_b16 v[40:41], v13 offset:16480
    ds_read_b64_tr_b16 v[42:43], v13 offset:17248
    v_mfma_f32_16x16x32_bf16 v[120:123], v[76:79], v[56:59], v[120:123]
    ds_read_b64_tr_b16 v[44:45], v12 offset:16512
    ds_read_b64_tr_b16 v[46:47], v12 offset:17280
    v_mfma_f32_16x16x32_bf16 v[124:127], v[76:79], v[60:63], v[124:127]
    ds_read_b64_tr_b16 v[48:49], v13 offset:16544
    ds_read_b64_tr_b16 v[50:51], v13 offset:17312
    v_mfma_f32_16x16x32_bf16 v[128:131], v[56:59], v[80:83], v[128:131]
    v_mfma_f32_16x16x32_bf16 v[132:135], v[60:63], v[80:83], v[132:135]
    v_mfma_f32_16x16x32_bf16 v[136:139], v[56:59], v[84:87], v[136:139]
    v_mfma_f32_16x16x32_bf16 v[140:143], v[60:63], v[84:87], v[140:143]
    s_waitcnt lgkmcnt(0)
    v_mfma_f32_16x16x32_bf16 v[96:99], v[28:31], v[20:23], v[96:99]
    s_barrier
    v_mfma_f32_16x16x32_bf16 v[100:103], v[28:31], v[24:27], v[100:103]
    ds_read_b128 v[56:59], v11 offset:16384
    ds_read_b128 v[60:63], v11 offset:18432
    v_mfma_f32_16x16x32_bf16 v[104:107], v[32:35], v[20:23], v[104:107]
    ds_read_b64_tr_b16 v[64:65], v12 offset:24576
    ds_read_b64_tr_b16 v[66:67], v12 offset:25344
    v_mfma_f32_16x16x32_bf16 v[108:111], v[32:35], v[24:27], v[108:111]
    ds_read_b64_tr_b16 v[68:69], v13 offset:24608
    ds_read_b64_tr_b16 v[70:71], v13 offset:25376
    v_mfma_f32_16x16x32_bf16 v[112:115], v[36:39], v[20:23], v[112:115]
    ds_read_b64_tr_b16 v[72:73], v12 offset:24640
    ds_read_b64_tr_b16 v[74:75], v12 offset:25408
    v_mfma_f32_16x16x32_bf16 v[116:119], v[36:39], v[24:27], v[116:119]
    ds_read_b64_tr_b16 v[76:77], v13 offset:24672
    ds_read_b64_tr_b16 v[78:79], v13 offset:25440
    v_mfma_f32_16x16x32_bf16 v[120:123], v[40:43], v[20:23], v[120:123]
    ds_read_b64_tr_b16 v[80:81], v12 offset:24704
    ds_read_b64_tr_b16 v[82:83], v12 offset:25472
    v_mfma_f32_16x16x32_bf16 v[124:127], v[40:43], v[24:27], v[124:127]
    ds_read_b64_tr_b16 v[84:85], v13 offset:24736
    ds_read_b64_tr_b16 v[86:87], v13 offset:25504
    v_mfma_f32_16x16x32_bf16 v[128:131], v[20:23], v[44:47], v[128:131]
    v_add_u32 v10, 32768, v10
    v_add_u32 v11, 32768, v11
    v_mfma_f32_16x16x32_bf16 v[132:135], v[24:27], v[44:47], v[132:135]
    v_mfma_f32_16x16x32_bf16 v[136:139], v[20:23], v[48:51], v[136:139]
    v_mfma_f32_16x16x32_bf16 v[140:143], v[24:27], v[48:51], v[140:143]
    s_add_u32 s65, s65, 1
    s_cmp_eq_u32 s65, 4
    s_waitcnt lgkmcnt(0)
    s_cbranch_scc1 L_qkv_last
    v_mfma_f32_16x16x32_bf16 v[96:99], v[64:67], v[56:59], v[96:99]
    s_barrier
    v_mfma_f32_16x16x32_bf16 v[100:103], v[64:67], v[60:63], v[100:103]
    ds_read_b128 v[20:23], v10 offset:0
    ds_read_b128 v[24:27], v10 offset:2048
    v_mfma_f32_16x16x32_bf16 v[104:107], v[68:71], v[56:59], v[104:107]
    ds_read_b64_tr_b16 v[28:29], v12 offset:0
    ds_read_b64_tr_b16 v[30:31], v12 offset:768
    v_mfma_f32_16x16x32_bf16 v[108:111], v[68:71], v[60:63], v[108:111]
    ds_read_b64_tr_b16 v[32:33], v13 offset:32
    ds_read_b64_tr_b16 v[34:35], v13 offset:800
    v_mfma_f32_16x16x32_bf16 v[112:115], v[72:75], v[56:59], v[112:115]
    ds_read_b64_tr_b16 v[36:37], v12 offset:64
    ds_read_b64_tr_b16 v[38:39], v12 offset:832
    v_mfma_f32_16x16x32_bf16 v[116:119], v[72:75], v[60:63], v[116:119]
    ds_read_b64_tr_b16 v[40:41], v13 offset:96
    ds_read_b64_tr_b16 v[42:43], v13 offset:864
    v_mfma_f32_16x16x32_bf16 v[120:123], v[76:79], v[56:59], v[120:123]
    ds_read_b64_tr_b16 v[44:45], v12 offset:128
    ds_read_b64_tr_b16 v[46:47], v12 offset:896
    v_mfma_f32_16x16x32_bf16 v[124:127], v[76:79], v[60:63], v[124:127]
    ds_read_b64_tr_b16 v[48:49], v13 offset:160
    ds_read_b64_tr_b16 v[50:51], v13 offset:928
    v_mfma_f32_16x16x32_bf16 v[128:131], v[56:59], v[80:83], v[128:131]
    v_mfma_f32_16x16x32_bf16 v[132:135], v[60:63], v[80:83], v[132:135]
    v_mfma_f32_16x16x32_bf16 v[136:139], v[56:59], v[84:87], v[136:139]
    v_mfma_f32_16x16x32_bf16 v[140:143], v[60:63], v[84:87], v[140:143]
    s_branch L_qkv_loop
L_qkv_last:
    v_mfma_f32_16x16x32_bf16 v[96:99], v[64:67], v[56:59], v[96:99]
    v_mov_b32 v7, 0
    buffer_load_dwordx2 v[154:155], v7, s[12:15], 0 offen sc1
    s_barrier
    v_mfma_f32_16x16x32_bf16 v[100:103], v[64:67], v[60:63], v[100:103]
    v_mfma_f32_16x16x32_bf16 v[104:107], v[68:71], v[56:59], v[104:107]
    v_mfma_f32_16x16x32_bf16 v[108:111], v[68:71], v[60:63], v[108:111]
    v_mfma_f32_16x16x32_bf16 v[112:115], v[72:75], v[56:59], v[112:115]
    v_mfma_f32_16x16x32_bf16 v[116:119], v[72:75], v[60:63], v[116:119]
    v_mfma_f32_16x16x32_bf16 v[120:123], v[76:79], v[56:59], v[120:123]
    v_mfma_f32_16x16x32_bf16 v[124:127], v[76:79], v[60:63], v[124:127]
    v_mfma_f32_16x16x32_bf16 v[128:131], v[56:59], v[80:83], v[128:131]
    v_mfma_f32_16x16x32_bf16 v[132:135], v[60:63], v[80:83], v[132:135]
    v_mfma_f32_16x16x32_bf16 v[136:139], v[56:59], v[84:87], v[136:139]
    v_mfma_f32_16x16x32_bf16 v[140:143], v[60:63], v[84:87], v[140:143]
    s_lshl_b32 s64, s18, 2
    s_add_u32 s64, s64, s17
    s_lshl_b32 s21, s64, 10
    s_lshl_b32 s22, s19, 18
    s_add_u32 s22, s22, s21
    s_lshl_b32 s63, s19, 17
    s_add_u32 s63, s63, s21
    s_add_u32 s63, s63, 4194304
    s_mov_b32 s23, 0x3eb8aa3b
    s_cmp_lt_u32 s19, 8
    s_cselect_b32 s70, s23, 1.0
    s_mov_b32 s71, s70
    s_barrier
    v_pk_mul_f32 v[96:97], v[96:97], s[70:71]
    v_pk_mul_f32 v[98:99], v[98:99], s[70:71]
    v_pk_mul_f32 v[100:101], v[100:101], s[70:71]
    v_pk_mul_f32 v[102:103], v[102:103], s[70:71]
    v_cvt_pk_bf16_f32 v24, v96, v97
    v_cvt_pk_bf16_f32 v25, v98, v99
    v_cvt_pk_bf16_f32 v26, v100, v101
    v_cvt_pk_bf16_f32 v27, v102, v103
    s_add_u32 s21, s22, 0
    v_permlane16_swap_b32 v24, v26
    v_permlane16_swap_b32 v25, v27
    buffer_store_dwordx4 v[24:27], v1, s[8:11], s21 offen sc1
    v_pk_mul_f32 v[104:105], v[104:105], s[70:71]
    v_pk_mul_f32 v[106:107], v[106:107], s[70:71]
    v_pk_mul_f32 v[108:109], v[108:109], s[70:71]
    v_pk_mul_f32 v[110:111], v[110:111], s[70:71]
    v_cvt_pk_bf16_f32 v28, v104, v105
    v_cvt_pk_bf16_f32 v29, v106, v107
    v_cvt_pk_bf16_f32 v30, v108, v109
    v_cvt_pk_bf16_f32 v31, v110, v111
    s_add_u32 s21, s22, 65536
    v_permlane16_swap_b32 v28, v30
    v_permlane16_swap_b32 v29, v31
    buffer_store_dwordx4 v[28:31], v1, s[8:11], s21 offen sc1
    v_pk_mul_f32 v[112:113], v[112:113], s[70:71]
    v_pk_mul_f32 v[114:115], v[114:115], s[70:71]
    v_pk_mul_f32 v[116:117], v[116:117], s[70:71]
    v_pk_mul_f32 v[118:119], v[118:119], s[70:71]
    v_cvt_pk_bf16_f32 v32, v112, v113
    v_cvt_pk_bf16_f32 v33, v114, v115
    v_cvt_pk_bf16_f32 v34, v116, v117
    v_cvt_pk_bf16_f32 v35, v118, v119
    s_add_u32 s21, s22, 131072
    v_permlane16_swap_b32 v32, v34
    v_permlane16_swap_b32 v33, v35
    buffer_store_dwordx4 v[32:35], v1, s[8:11], s21 offen sc1
    s_barrier
    v_pk_mul_f32 v[120:121], v[120:121], s[70:71]
    v_pk_mul_f32 v[122:123], v[122:123], s[70:71]
    v_pk_mul_f32 v[124:125], v[124:125], s[70:71]
    v_pk_mul_f32 v[126:127], v[126:127], s[70:71]
    v_cvt_pk_bf16_f32 v36, v120, v121
    v_cvt_pk_bf16_f32 v37, v122, v123
    v_cvt_pk_bf16_f32 v38, v124, v125
    v_cvt_pk_bf16_f32 v39, v126, v127
    s_add_u32 s21, s22, 196608
    v_permlane16_swap_b32 v36, v38
    v_permlane16_swap_b32 v37, v39
    buffer_store_dwordx4 v[36:39], v1, s[8:11], s21 offen sc1
    v_cvt_pk_bf16_f32 v40, v128, v129
    v_cvt_pk_bf16_f32 v41, v130, v131
    v_cvt_pk_bf16_f32 v42, v132, v133
    v_cvt_pk_bf16_f32 v43, v134, v135
    s_add_u32 s21, s63, 0
    v_permlane32_swap_b32 v40, v42
    v_permlane32_swap_b32 v41, v43
    buffer_store_dwordx4 v[40:43], v1, s[8:11], s21 offen sc1
    v_cvt_pk_bf16_f32 v44, v136, v137
    v_cvt_pk_bf16_f32 v45, v138, v139
    v_cvt_pk_bf16_f32 v46, v140, v141
    v_cvt_pk_bf16_f32 v47, v142, v143
    s_add_u32 s21, s63, 65536
    v_permlane32_swap_b32 v44, v46
    v_permlane32_swap_b32 v45, v47
    buffer_store_dwordx4 v[44:47], v1, s[8:11], s21 offen sc1
    s_lshl_b32 s63, s19, 6
    s_add_u32 s63, s63, s64
    s_lshl_b32 s63, s63, 7
    s_add_u32 s63, s63, 10485760
    s_barrier
    s_barrier
    s_barrier
    s_barrier
    s_waitcnt vmcnt(0)
L_epa:
    v_cmp_ne_u32 vcc, 0, v154
    s_cbranch_vccnz L_epoka
    v_mov_b32 v3, 0
    buffer_load_dwordx2 v[154:155], v3, s[12:15], 0 offen sc1
    s_sub_u32 s20, s20, 1
    s_waitcnt vmcnt(0)
    s_cbranch_scc0 L_epa
    s_mov_b32 s20, 0
L_epoka:
    v_mov_b32 v3, 0
    s_mov_b64 exec, 1
    buffer_store_dwordx2 v[154:155], v3, s[8:11], s63 offen sc1
    s_mov_b64 exec, -1
    s_barrier
    s_barrier
    s_barrier
    s_barrier
    s_barrier
    s_barrier
    s_barrier
    s_barrier
    buffer_load_dwordx2 v[158:159], v156, s[8:11], 0 offen sc1
    s_barrier
    s_barrier
    s_setprio 3
L_a_try:
    s_waitcnt vmcnt(0)
    v_cmp_ne_u64 vcc, v[158:159], v[154:155]
    s_nop 0
    s_cmp_eq_u64 vcc, 0
    s_cbranch_scc1 L_a_go
    s_sleep 4
    buffer_load_dwordx2 v[158:159], v156, s[8:11], 0 offen sc1
    s_sub_u32 s20, s20, 1
    s_cbranch_scc0 L_a_try
    s_mov_b32 s20, 0
    s_waitcnt vmcnt(0)
L_a_go:
    s_lshl_b32 s22, s17, 10
    v_xor_b32 v5, s22, v1
    s_mov_b32 m0, s35
    s_mov_b32 s31, 0
    buffer_load_dwordx4 v[8:11], v5, s[8:11], s34 offen sc1
    v_xor_b32 v6, 1024, v5
    buffer_load_dwordx4 v[12:15], v6, s[8:11], s34 offen sc1
    v_xor_b32 v6, 2048, v5
    buffer_load_dwordx4 v[16:19], v6, s[8:11], s34 offen sc1
    v_xor_b32 v6, 3072, v5
    buffer_load_dwordx4 v[20:23], v6, s[8:11], s34 offen sc1
L_prea:
    buffer_load_dwordx4 v1, s[24:27], s30 offen sc1 lds
    s_add_u32 m0, m0, 1024
    s_add_u32 s31, s31, 1
    buffer_load_dwordx4 v2, s[24:27], s30 offen sc1 lds
    s_add_u32 m0, m0, 1024
    s_add_u32 s30, s30, 1024
    s_cmp_lt_u32 s31, 6
    s_cbranch_scc1 L_prea
    s_lshl_b32 s21, s29, 2
    s_add_u32 s21, s21, s17
    s_lshl_b32 s21, s21, 7
    s_add_u32 s21, s21, 8388608
    v_and_b32 v3, 31, v0
    v_lshlrev_b32 v3, 2, v3
    buffer_load_dword v7, v3, s[8:11], s21 offen sc1
    s_branch L_at_body
L_ffn:
    s_mov_b32 s56, s34
    s_mov_b32 s57, s35
    s_mov_b32 s58, 3584
    s_mov_b32 s59, 0x00020000
    s_mov_b32 s52, s32
    s_mov_b32 s53, s33
    s_mov_b32 s54, 1835008
    s_mov_b32 s55, 0x00020000
    s_mul_i32 s22, s19, 224
    v_lshlrev_b32 v9, 3, v3
    s_barrier
    s_barrier
    buffer_load_dwordx2 v[56:57], v9, s[56:59], s22 offen offset:0
    buffer_load_dwordx2 v[58:59], v9, s[56:59], s22 offen offset:32
    buffer_load_dwordx2 v[60:61], v9, s[56:59], s22 offen offset:64
    buffer_load_dwordx2 v[62:63], v9, s[56:59], s22 offen offset:96
    buffer_load_dwordx2 v[64:65], v9, s[56:59], s22 offen offset:128
    buffer_load_dwordx2 v[66:67], v9, s[56:59], s22 offen offset:160
    buffer_load_dwordx2 v[68:69], v9, s[56:59], s22 offen offset:192
    s_and_b32 s21, s18, 7
    s_lshl_b32 s21, s21, 2
    s_add_u32 s21, s21, s17
    s_mul_i32 s21, s21, 57344
    s_add_u32 s21, s21, s22
    v_mul_u32_u24 v6, 3584, v2
    v_mul_u32_u24 v9, 72, v3
    v_add_u32 v6, v6, v9
    v_lshlrev_b32 v7, 8, v7
    v_lshl_add_u32 v7, v5, 3, v7
    v_add_u32 v7, 131072, v7
    v_lshl_add_u32 v8, v8, 2, v4
    v_add_u32 v9, 0, v8
    v_and_b32 v9, 7, v9
    v_lshl_add_u32 v12, v9, 5, v7
    v_add_u32 v9, 1, v8
    v_and_b32 v9, 7, v9
    v_lshl_add_u32 v13, v9, 5, v7
    v_add_u32 v9, 2, v8
    v_and_b32 v9, 7, v9
    v_lshl_add_u32 v14, v9, 5, v7
    v_add_u32 v9, 3, v8
    v_and_b32 v9, 7, v9
    v_lshl_add_u32 v15, v9, 5, v7
    v_add_u32 v9, 4, v8
    v_and_b32 v9, 7, v9
    v_lshl_add_u32 v16, v9, 5, v7
    v_add_u32 v9, 5, v8
    v_and_b32 v9, 7, v9
    v_lshl_add_u32 v17, v9, 5, v7
    v_add_u32 v9, 6, v8
    v_and_b32 v9, 7, v9
    v_lshl_add_u32 v18, v9, 5, v7
    s_barrier
    s_barrier
    s_and_b32 s21, s2, 7
    s_lshl_b32 s28, s21, 1
    s_bfe_u32 s21, s2, 0x10003
    s_add_u32 s28, s28, s21
    s_add_u32 s28, s28, 16
    s_bfe_u32 s29, s2, 0x40004
    s_mov_b32 s24, s8
    s_mov_b32 s25, s9
    s_mov_b32 s26, 20971520
    s_mov_b32 s27, 0x00020000
    s_mov_b32 s32, 0x0000ffff
    s_mov_b32 s33, 0x0000ffff
    s_lshl_b32 s21, s28, 16
    s_lshl_b32 s22, s29, 12
    s_add_u32 s34, s21, s22
    s_lshl_b32 s22, s17, 14
    s_add_u32 s30, s21, s22
    s_add_u32 s30, s30, 2097152
    s_mov_b32 s38, 49152
    s_mov_b32 s39, 147460
    s_mov_b32 s42, 0
    s_lshl_b32 s43, s18, 2
    s_add_u32 s43, s43, s17
    s_lshl_b32 s43, s43, 4
    s_add_u32 s43, s43, s19
    s_lshl_b32 s43, s43, 7
    s_add_u32 s43, s43, 10747904
    s_mul_i32 s35, s17, 12288
    s_add_u32 s35, s35, s38
    v_lshlrev_b32 v1, 4, v0
    v_add_u32 v2, 2097152, v1
    s_lshr_b32 s21, s28, 2
    s_lshl_b32 s21, s21, 6
    s_lshl_b32 s22, s17, 4
    s_add_u32 s23, s21, s22
    s_add_u32 s23, s23, 512
    v_add_u32 v156, s23, v0
    s_lshr_b32 s23, s28, 1
    s_lshl_b32 s23, s23, 6
    s_add_u32 s23, s23, s22
    s_sub_u32 s23, s23, 16
    v_add_u32 v3, s23, v0
    v_cmp_le_u32 vcc, 16, v0
    s_nop 1
    v_cndmask_b32 v156, v156, v3, vcc
    s_lshl_b32 s22, s29, 2
    s_add_u32 s23, s21, s22
    s_sub_u32 s23, s23, 32
    v_add_u32 v3, s23, v0
    v_cmp_le_u32 vcc, 32, v0
    s_nop 1
    v_cndmask_b32 v156, v156, v3, vcc
    s_lshl_b32 s23, s17, 8
    s_add_u32 s23, s23, s22
    v_and_b32 v3, 3, v0
    v_lshlrev_b32 v3, 6, v3
    v_add_u32 v3, s23, v3
    v_cmp_le_u32 vcc, 36, v0
    s_nop 1
    v_cndmask_b32 v156, v156, v3, vcc
    v_lshlrev_b32 v156, 7, v156
    v_add_u32 v156, 10485760, v156
    s_barrier
    s_barrier
    v_mov_b32 v24, -1
    v_mov_b32 v25, -1
    v_mov_b32 v26, -1
    v_mov_b32 v27, -1
    s_lshl_b32 s21, s29, 2
    s_add_u32 s21, s21, s17
    s_lshl_b32 s21, s21, 5
    s_add_u32 s21, s21, s28
    s_lshl_b32 s21, s21, 10
    s_add_u32 s21, s21, 6291456
    s_sub_u32 s22, s21, 16384
    buffer_store_dwordx4 v[24:27], v1, s[8:11], s21 offen sc1
    buffer_store_dwordx4 v[24:27], v1, s[8:11], s22 offen sc1
    s_barrier
    s_barrier
    s_barrier
    s_barrier
    s_barrier
    s_barrier
    s_barrier
    s_waitcnt vmcnt(0)
    v_lshlrev_b32 v96, 16, v56
    v_and_b32 v97, 0xffff0000, v56
    v_lshlrev_b32 v98, 16, v57
    v_and_b32 v99, 0xffff0000, v57
    v_lshlrev_b32 v100, 16, v56
    v_and_b32 v101, 0xffff0000, v56
    v_lshlrev_b32 v102, 16, v57
    v_and_b32 v103, 0xffff0000, v57
    v_lshlrev_b32 v104, 16, v58
    v_and_b32 v105, 0xffff0000, v58
    v_lshlrev_b32 v106, 16, v59
    v_and_b32 v107, 0xffff0000, v59
    v_lshlrev_b32 v108, 16, v58
    v_and_b32 v109, 0xffff0000, v58
    v_lshlrev_b32 v110, 16, v59
    v_and_b32 v111, 0xffff0000, v59
    v_lshlrev_b32 v112, 16, v60
    v_and_b32 v113, 0xffff0000, v60
    v_lshlrev_b32 v114, 16, v61
    v_and_b32 v115, 0xffff0000, v61
    v_lshlrev_b32 v116, 16, v60
    v_and_b32 v117, 0xffff0000, v60
    v_lshlrev_b32 v118, 16, v61
    v_and_b32 v119, 0xffff0000, v61
    s_barrier
    v_lshlrev_b32 v120, 16, v62
    v_and_b32 v121, 0xffff0000, v62
    v_lshlrev_b32 v122, 16, v63
    v_and_b32 v123, 0xffff0000, v63
    v_lshlrev_b32 v124, 16, v62
    v_and_b32 v125, 0xffff0000, v62
    v_lshlrev_b32 v126, 16, v63
    v_and_b32 v127, 0xffff0000, v63
    v_lshlrev_b32 v128, 16, v64
    v_and_b32 v129, 0xffff0000, v64
    v_lshlrev_b32 v130, 16, v65
    v_and_b32 v131, 0xffff0000, v65
    v_lshlrev_b32 v132, 16, v64
    v_and_b32 v133, 0xffff0000, v64
    v_lshlrev_b32 v134, 16, v65
    v_and_b32 v135, 0xffff0000, v65
    v_lshlrev_b32 v136, 16, v66
    v_and_b32 v137, 0xffff0000, v66
    v_lshlrev_b32 v138, 16, v67
    v_and_b32 v139, 0xffff0000, v67
    v_lshlrev_b32 v140, 16, v66
    v_and_b32 v141, 0xffff0000, v66
    v_lshlrev_b32 v142, 16, v67
    v_and_b32 v143, 0xffff0000, v67
    s_barrier
    v_lshlrev_b32 v144, 16, v68
    v_and_b32 v145, 0xffff0000, v68
    v_lshlrev_b32 v146, 16, v69
    v_and_b32 v147, 0xffff0000, v69
    v_lshlrev_b32 v148, 16, v68
    v_and_b32 v149, 0xffff0000, v68
    v_lshlrev_b32 v150, 16, v69
    v_and_b32 v151, 0xffff0000, v69
    s_barrier
    s_setprio 1
    s_barrier
    ds_read_b128 v[20:23], v10 offset:0
    ds_read_b128 v[24:27], v10 offset:2048
    ds_read_b64_tr_b16 v[28:29], v12 offset:0
    ds_read_b64_tr_b16 v[30:31], v12 offset:1024
    ds_read_b64_tr_b16 v[32:33], v13 offset:0
    ds_read_b64_tr_b16 v[34:35], v13 offset:1024
    ds_read_b64_tr_b16 v[36:37], v14 offset:0
    ds_read_b64_tr_b16 v[38:39], v14 offset:1024
    ds_read_b64_tr_b16 v[40:41], v15 offset:0
    ds_read_b64_tr_b16 v[42:43], v15 offset:1024
    ds_read_b64_tr_b16 v[44:45], v16 offset:0
    ds_read_b64_tr_b16 v[46:47], v16 offset:1024
    ds_read_b64_tr_b16 v[48:49], v17 offset:0
    ds_read_b64_tr_b16 v[50:51], v17 offset:1024
    ds_read_b64_tr_b16 v[52:53], v18 offset:0
    ds_read_b64_tr_b16 v[54:55], v18 offset:1024
.p2align 6
L_ffn_loop:
    s_waitcnt lgkmcnt(0)
    v_mfma_f32_16x16x32_bf16 v[96:99], v[28:31], v[20:23], v[96:99]
    s_barrier
    v_mfma_f32_16x16x32_bf16 v[100:103], v[28:31], v[24:27], v[100:103]
    ds_read_b128 v[56:59], v11 offset:0
    ds_read_b128 v[60:63], v11 offset:2048
    v_mfma_f32_16x16x32_bf16 v[104:107], v[32:35], v[20:23], v[104:107]
    ds_read_b64_tr_b16 v[64:65], v12 offset:8192
    ds_read_b64_tr_b16 v[66:67], v12 offset:9216
    v_mfma_f32_16x16x32_bf16 v[108:111], v[32:35], v[24:27], v[108:111]
    ds_read_b64_tr_b16 v[68:69], v13 offset:8192
    ds_read_b64_tr_b16 v[70:71], v13 offset:9216
    v_mfma_f32_16x16x32_bf16 v[112:115], v[36:39], v[20:23], v[112:115]
    ds_read_b64_tr_b16 v[72:73], v14 offset:8192
    ds_read_b64_tr_b16 v[74:75], v14 offset:9216
    v_mfma_f32_16x16x32_bf16 v[116:119], v[36:39], v[24:27], v[116:119]
    ds_read_b64_tr_b16 v[76:77], v15 offset:8192
    ds_read_b64_tr_b16 v[78:79], v15 offset:9216
    v_mfma_f32_16x16x32_bf16 v[120:123], v[40:43], v[20:23], v[120:123]
    ds_read_b64_tr_b16 v[80:81], v16 offset:8192
    ds_read_b64_tr_b16 v[82:83], v16 offset:9216
    v_mfma_f32_16x16x32_bf16 v[124:127], v[40:43], v[24:27], v[124:127]
    ds_read_b64_tr_b16 v[84:85], v17 offset:8192
    ds_read_b64_tr_b16 v[86:87], v17 offset:9216
    v_mfma_f32_16x16x32_bf16 v[128:131], v[44:47], v[20:23], v[128:131]
    ds_read_b64_tr_b16 v[88:89], v18 offset:8192
    ds_read_b64_tr_b16 v[90:91], v18 offset:9216
    v_mfma_f32_16x16x32_bf16 v[132:135], v[44:47], v[24:27], v[132:135]
    v_mfma_f32_16x16x32_bf16 v[136:139], v[48:51], v[20:23], v[136:139]
    v_mfma_f32_16x16x32_bf16 v[140:143], v[48:51], v[24:27], v[140:143]
    v_mfma_f32_16x16x32_bf16 v[144:147], v[52:55], v[20:23], v[144:147]
    v_mfma_f32_16x16x32_bf16 v[148:151], v[52:55], v[24:27], v[148:151]
    s_waitcnt lgkmcnt(0)
    v_mfma_f32_16x16x32_bf16 v[96:99], v[64:67], v[56:59], v[96:99]
    s_barrier
    v_mfma_f32_16x16x32_bf16 v[100:103], v[64:67], v[60:63], v[100:103]
    ds_read_b128 v[20:23], v10 offset:16384
    ds_read_b128 v[24:27], v10 offset:18432
    v_mfma_f32_16x16x32_bf16 v[104:107], v[68:71], v[56:59], v[104:107]
    ds_read_b64_tr_b16 v[28:29], v12 offset:16384
    ds_read_b64_tr_b16 v[30:31], v12 offset:17408
    v_mfma_f32_16x16x32_bf16 v[108:111], v[68:71], v[60:63], v[108:111]
    ds_read_b64_tr_b16 v[32:33], v13 offset:16384
    ds_read_b64_tr_b16 v[34:35], v13 offset:17408
    v_mfma_f32_16x16x32_bf16 v[112:115], v[72:75], v[56:59], v[112:115]
    ds_read_b64_tr_b16 v[36:37], v14 offset:16384
    ds_read_b64_tr_b16 v[38:39], v14 offset:17408
    v_mfma_f32_16x16x32_bf16 v[116:119], v[72:75], v[60:63], v[116:119]
    ds_read_b64_tr_b16 v[40:41], v15 offset:16384
    ds_read_b64_tr_b16 v[42:43], v15 offset:17408
    v_mfma_f32_16x16x32_bf16 v[120:123], v[76:79], v[56:59], v[120:123]
    ds_read_b64_tr_b16 v[44:45], v16 offset:16384
    ds_read_b64_tr_b16 v[46:47], v16 offset:17408
    v_mfma_f32_16x16x32_bf16 v[124:127], v[76:79], v[60:63], v[124:127]
    ds_read_b64_tr_b16 v[48:49], v17 offset:16384
    ds_read_b64_tr_b16 v[50:51], v17 offset:17408
    v_mfma_f32_16x16x32_bf16 v[128:131], v[80:83], v[56:59], v[128:131]
    ds_read_b64_tr_b16 v[52:53], v18 offset:16384
    ds_read_b64_tr_b16 v[54:55], v18 offset:17408
    v_mfma_f32_16x16x32_bf16 v[132:135], v[80:83], v[60:63], v[132:135]
    v_mfma_f32_16x16x32_bf16 v[136:139], v[84:87], v[56:59], v[136:139]
    v_mfma_f32_16x16x32_bf16 v[140:143], v[84:87], v[60:63], v[140:143]
    v_mfma_f32_16x16x32_bf16 v[144:147], v[88:91], v[56:59], v[144:147]
    v_mfma_f32_16x16x32_bf16 v[148:151], v[88:91], v[60:63], v[148:151]
    s_waitcnt lgkmcnt(0)
    v_mfma_f32_16x16x32_bf16 v[96:99], v[28:31], v[20:23], v[96:99]
    s_barrier
    v_mfma_f32_16x16x32_bf16 v[100:103], v[28:31], v[24:27], v[100:103]
    ds_read_b128 v[56:59], v11 offset:16384
    ds_read_b128 v[60:63], v11 offset:18432
    v_mfma_f32_16x16x32_bf16 v[104:107], v[32:35], v[20:23], v[104:107]
    ds_read_b64_tr_b16 v[64:65], v12 offset:24576
    ds_read_b64_tr_b16 v[66:67], v12 offset:25600
    v_mfma_f32_16x16x32_bf16 v[108:111], v[32:35], v[24:27], v[108:111]
    ds_read_b64_tr_b16 v[68:69], v13 offset:24576
    ds_read_b64_tr_b16 v[70:71], v13 offset:25600
    v_mfma_f32_16x16x32_bf16 v[112:115], v[36:39], v[20:23], v[112:115]
    ds_read_b64_tr_b16 v[72:73], v14 offset:24576
    ds_read_b64_tr_b16 v[74:75], v14 offset:25600
    v_mfma_f32_16x16x32_bf16 v[116:119], v[36:39], v[24:27], v[116:119]
    ds_read_b64_tr_b16 v[76:77], v15 offset:24576
    ds_read_b64_tr_b16 v[78:79], v15 offset:25600
    v_mfma_f32_16x16x32_bf16 v[120:123], v[40:43], v[20:23], v[120:123]
    ds_read_b64_tr_b16 v[80:81], v16 offset:24576
    ds_read_b64_tr_b16 v[82:83], v16 offset:25600
    v_mfma_f32_16x16x32_bf16 v[124:127], v[40:43], v[24:27], v[124:127]
    ds_read_b64_tr_b16 v[84:85], v17 offset:24576
    ds_read_b64_tr_b16 v[86:87], v17 offset:25600
    v_mfma_f32_16x16x32_bf16 v[128:131], v[44:47], v[20:23], v[128:131]
    ds_read_b64_tr_b16 v[88:89], v18 offset:24576
    ds_read_b64_tr_b16 v[90:91], v18 offset:25600
    v_mfma_f32_16x16x32_bf16 v[132:135], v[44:47], v[24:27], v[132:135]
    v_add_u32 v10, 32768, v10
    v_add_u32 v11, 32768, v11
    v_mfma_f32_16x16x32_bf16 v[136:139], v[48:51], v[20:23], v[136:139]
    v_mfma_f32_16x16x32_bf16 v[140:143], v[48:51], v[24:27], v[140:143]
    v_mfma_f32_16x16x32_bf16 v[144:147], v[52:55], v[20:23], v[144:147]
    v_mfma_f32_16x16x32_bf16 v[148:151], v[52:55], v[24:27], v[148:151]
    s_add_u32 s65, s65, 1
    s_cmp_eq_u32 s65, 4
    s_waitcnt lgkmcnt(0)
    s_cbranch_scc1 L_ffn_last
    v_mfma_f32_16x16x32_bf16 v[96:99], v[64:67], v[56:59], v[96:99]
    s_barrier
    v_mfma_f32_16x16x32_bf16 v[100:103], v[64:67], v[60:63], v[100:103]
    ds_read_b128 v[20:23], v10 offset:0
    ds_read_b128 v[24:27], v10 offset:2048
    v_mfma_f32_16x16x32_bf16 v[104:107], v[68:71], v[56:59], v[104:107]
    ds_read_b64_tr_b16 v[28:29], v12 offset:0
    ds_read_b64_tr_b16 v[30:31], v12 offset:1024
    v_mfma_f32_16x16x32_bf16 v[108:111], v[68:71], v[60:63], v[108:111]
    ds_read_b64_tr_b16 v[32:33], v13 offset:0
    ds_read_b64_tr_b16 v[34:35], v13 offset:1024
    v_mfma_f32_16x16x32_bf16 v[112:115], v[72:75], v[56:59], v[112:115]
    ds_read_b64_tr_b16 v[36:37], v14 offset:0
    ds_read_b64_tr_b16 v[38:39], v14 offset:1024
    v_mfma_f32_16x16x32_bf16 v[116:119], v[72:75], v[60:63], v[116:119]
    ds_read_b64_tr_b16 v[40:41], v15 offset:0
    ds_read_b64_tr_b16 v[42:43], v15 offset:1024
    v_mfma_f32_16x16x32_bf16 v[120:123], v[76:79], v[56:59], v[120:123]
    ds_read_b64_tr_b16 v[44:45], v16 offset:0
    ds_read_b64_tr_b16 v[46:47], v16 offset:1024
    v_mfma_f32_16x16x32_bf16 v[124:127], v[76:79], v[60:63], v[124:127]
    ds_read_b64_tr_b16 v[48:49], v17 offset:0
    ds_read_b64_tr_b16 v[50:51], v17 offset:1024
    v_mfma_f32_16x16x32_bf16 v[128:131], v[80:83], v[56:59], v[128:131]
    ds_read_b64_tr_b16 v[52:53], v18 offset:0
    ds_read_b64_tr_b16 v[54:55], v18 offset:1024
    v_mfma_f32_16x16x32_bf16 v[132:135], v[80:83], v[60:63], v[132:135]
    v_mfma_f32_16x16x32_bf16 v[136:139], v[84:87], v[56:59], v[136:139]
    v_mfma_f32_16x16x32_bf16 v[140:143], v[84:87], v[60:63], v[140:143]
    v_mfma_f32_16x16x32_bf16 v[144:147], v[88:91], v[56:59], v[144:147]
    v_mfma_f32_16x16x32_bf16 v[148:151], v[88:91], v[60:63], v[148:151]
    s_branch L_ffn_loop
L_ffn_last:
    v_mfma_f32_16x16x32_bf16 v[96:99], v[64:67], v[56:59], v[96:99]
    v_mov_b32 v7, 0
    buffer_load_dwordx2 v[154:155], v7, s[12:15], 0 offen sc1
    s_barrier
    v_mfma_f32_16x16x32_bf16 v[100:103], v[64:67], v[60:63], v[100:103]
    v_mfma_f32_16x16x32_bf16 v[104:107], v[68:71], v[56:59], v[104:107]
    v_mfma_f32_16x16x32_bf16 v[108:111], v[68:71], v[60:63], v[108:111]
    v_mfma_f32_16x16x32_bf16 v[112:115], v[72:75], v[56:59], v[112:115]
    v_mfma_f32_16x16x32_bf16 v[116:119], v[72:75], v[60:63], v[116:119]
    v_mfma_f32_16x16x32_bf16 v[120:123], v[76:79], v[56:59], v[120:123]
    v_mfma_f32_16x16x32_bf16 v[124:127], v[76:79], v[60:63], v[124:127]
    v_mfma_f32_16x16x32_bf16 v[128:131], v[80:83], v[56:59], v[128:131]
    v_mfma_f32_16x16x32_bf16 v[132:135], v[80:83], v[60:63], v[132:135]
    v_mfma_f32_16x16x32_bf16 v[136:139], v[84:87], v[56:59], v[136:139]
    v_mfma_f32_16x16x32_bf16 v[140:143], v[84:87], v[60:63], v[140:143]
    v_mfma_f32_16x16x32_bf16 v[144:147], v[88:91], v[56:59], v[144:147]
    v_mfma_f32_16x16x32_bf16 v[148:151], v[88:91], v[60:63], v[148:151]
    s_lshl_b32 s64, s18, 2
    s_add_u32 s64, s64, s17
    s_mul_i32 s63, s64, 112
    s_mul_i32 s22, s19, 7
    s_add_u32 s63, s63, s22
    s_lshl_b32 s63, s63, 10
    s_add_u32 s63, s63, 12582912
    s_add_u32 s64, s63, 4096
    s_mov_b32 s70, 0x3fb8aa3b
    s_mov_b32 s71, 0x3fb8aa3b
    s_setprio 2
    v_pk_mul_f32 v[56:57], v[96:97], s[70:71]
    v_pk_mul_f32 v[58:59], v[98:99], s[70:71]
    v_pk_mul_f32 v[60:61], v[100:101], s[70:71]
    v_pk_mul_f32 v[62:63], v[102:103], s[70:71]
    v_exp_f32 v56, v56
    v_exp_f32 v57, v57
    v_exp_f32 v58, v58
    v_exp_f32 v59, v59
    v_exp_f32 v60, v60
    v_exp_f32 v61, v61
    v_exp_f32 v62, v62
    v_exp_f32 v63, v63
    v_pk_add_f32 v[56:57], v[56:57], 1.0 op_sel_hi:[1,0]
    v_pk_add_f32 v[58:59], v[58:59], 1.0 op_sel_hi:[1,0]
    v_pk_add_f32 v[60:61], v[60:61], 1.0 op_sel_hi:[1,0]
    v_pk_add_f32 v[62:63], v[62:63], 1.0 op_sel_hi:[1,0]
    v_pk_fma_f32 v[64:65], v[56:57], v[56:57], 1.0 op_sel_hi:[1,1,0]
    v_pk_fma_f32 v[66:67], v[58:59], v[58:59], 1.0 op_sel_hi:[1,1,0]
    v_pk_fma_f32 v[68:69], v[60:61], v[60:61], 1.0 op_sel_hi:[1,1,0]
    v_pk_fma_f32 v[70:71], v[62:63], v[62:63], 1.0 op_sel_hi:[1,1,0]
    v_rcp_f32 v64, v64
    v_rcp_f32 v65, v65
    v_rcp_f32 v66, v66
    v_rcp_f32 v67, v67
    v_rcp_f32 v68, v68
    v_rcp_f32 v69, v69
    v_rcp_f32 v70, v70
    v_rcp_f32 v71, v71
    v_pk_mul_f32 v[64:65], v[64:65], v[96:97]
    v_pk_mul_f32 v[66:67], v[66:67], v[98:99]
    v_pk_mul_f32 v[68:69], v[68:69], v[100:101]
    v_pk_mul_f32 v[70:71], v[70:71], v[102:103]
    v_pk_fma_f32 v[64:65], v[64:65], -2.0, v[96:97] op_sel_hi:[1,0,1]
    v_pk_fma_f32 v[66:67], v[66:67], -2.0, v[98:99] op_sel_hi:[1,0,1]
    v_pk_fma_f32 v[68:69], v[68:69], -2.0, v[100:101] op_sel_hi:[1,0,1]
    v_pk_fma_f32 v[70:71], v[70:71], -2.0, v[102:103] op_sel_hi:[1,0,1]
    v_cvt_pk_bf16_f32 v24, v64, v65
    v_cvt_pk_bf16_f32 v25, v66, v67
    v_cvt_pk_bf16_f32 v26, v68, v69
    v_cvt_pk_bf16_f32 v27, v70, v71
    s_nop 0
    v_permlane16_swap_b32 v24, v26
    v_permlane16_swap_b32 v25, v27
    v_pk_mul_f32 v[56:57], v[104:105], s[70:71]
    v_pk_mul_f32 v[58:59], v[106:107], s[70:71]
    v_pk_mul_f32 v[60:61], v[108:109], s[70:71]
    v_pk_mul_f32 v[62:63], v[110:111], s[70:71]
    v_exp_f32 v56, v56
    v_exp_f32 v57, v57
    v_exp_f32 v58, v58
    v_exp_f32 v59, v59
    v_exp_f32 v60, v60
    v_exp_f32 v61, v61
    v_exp_f32 v62, v62
    v_exp_f32 v63, v63
    v_pk_add_f32 v[56:57], v[56:57], 1.0 op_sel_hi:[1,0]
    v_pk_add_f32 v[58:59], v[58:59], 1.0 op_sel_hi:[1,0]
    v_pk_add_f32 v[60:61], v[60:61], 1.0 op_sel_hi:[1,0]
    v_pk_add_f32 v[62:63], v[62:63], 1.0 op_sel_hi:[1,0]
    v_pk_fma_f32 v[64:65], v[56:57], v[56:57], 1.0 op_sel_hi:[1,1,0]
    v_pk_fma_f32 v[66:67], v[58:59], v[58:59], 1.0 op_sel_hi:[1,1,0]
    v_pk_fma_f32 v[68:69], v[60:61], v[60:61], 1.0 op_sel_hi:[1,1,0]
    v_pk_fma_f32 v[70:71], v[62:63], v[62:63], 1.0 op_sel_hi:[1,1,0]
    v_rcp_f32 v64, v64
    v_rcp_f32 v65, v65
    v_rcp_f32 v66, v66
    v_rcp_f32 v67, v67
    v_rcp_f32 v68, v68
    v_rcp_f32 v69, v69
    v_rcp_f32 v70, v70
    v_rcp_f32 v71, v71
    v_pk_mul_f32 v[64:65], v[64:65], v[104:105]
    v_pk_mul_f32 v[66:67], v[66:67], v[106:107]
    v_pk_mul_f32 v[68:69], v[68:69], v[108:109]
    v_pk_mul_f32 v[70:71], v[70:71], v[110:111]
    v_pk_fma_f32 v[64:65], v[64:65], -2.0, v[104:105] op_sel_hi:[1,0,1]
    v_pk_fma_f32 v[66:67], v[66:67], -2.0, v[106:107] op_sel_hi:[1,0,1]
    v_pk_fma_f32 v[68:69], v[68:69], -2.0, v[108:109] op_sel_hi:[1,0,1]
    v_pk_fma_f32 v[70:71], v[70:71], -2.0, v[110:111] op_sel_hi:[1,0,1]
    v_cvt_pk_bf16_f32 v28, v64, v65
    v_cvt_pk_bf16_f32 v29, v66, v67
    v_cvt_pk_bf16_f32 v30, v68, v69
    v_cvt_pk_bf16_f32 v31, v70, v71
    s_nop 0
    v_permlane16_swap_b32 v28, v30
    v_permlane16_swap_b32 v29, v31
    v_pk_mul_f32 v[56:57], v[112:113], s[70:71]
    v_pk_mul_f32 v[58:59], v[114:115], s[70:71]
    v_pk_mul_f32 v[60:61], v[116:117], s[70:71]
    v_pk_mul_f32 v[62:63], v[118:119], s[70:71]
    v_exp_f32 v56, v56
    v_exp_f32 v57, v57
    v_exp_f32 v58, v58
    v_exp_f32 v59, v59
    v_exp_f32 v60, v60
    v_exp_f32 v61, v61
    v_exp_f32 v62, v62
    v_exp_f32 v63, v63
    v_pk_add_f32 v[56:57], v[56:57], 1.0 op_sel_hi:[1,0]
    v_pk_add_f32 v[58:59], v[58:59], 1.0 op_sel_hi:[1,0]
    v_pk_add_f32 v[60:61], v[60:61], 1.0 op_sel_hi:[1,0]
    v_pk_add_f32 v[62:63], v[62:63], 1.0 op_sel_hi:[1,0]
    v_pk_fma_f32 v[64:65], v[56:57], v[56:57], 1.0 op_sel_hi:[1,1,0]
    v_pk_fma_f32 v[66:67], v[58:59], v[58:59], 1.0 op_sel_hi:[1,1,0]
    v_pk_fma_f32 v[68:69], v[60:61], v[60:61], 1.0 op_sel_hi:[1,1,0]
    v_pk_fma_f32 v[70:71], v[62:63], v[62:63], 1.0 op_sel_hi:[1,1,0]
    v_rcp_f32 v64, v64
    v_rcp_f32 v65, v65
    v_rcp_f32 v66, v66
    v_rcp_f32 v67, v67
    v_rcp_f32 v68, v68
    v_rcp_f32 v69, v69
    v_rcp_f32 v70, v70
    v_rcp_f32 v71, v71
    v_pk_mul_f32 v[64:65], v[64:65], v[112:113]
    v_pk_mul_f32 v[66:67], v[66:67], v[114:115]
    v_pk_mul_f32 v[68:69], v[68:69], v[116:117]
    v_pk_mul_f32 v[70:71], v[70:71], v[118:119]
    v_pk_fma_f32 v[64:65], v[64:65], -2.0, v[112:113] op_sel_hi:[1,0,1]
    v_pk_fma_f32 v[66:67], v[66:67], -2.0, v[114:115] op_sel_hi:[1,0,1]
    v_pk_fma_f32 v[68:69], v[68:69], -2.0, v[116:117] op_sel_hi:[1,0,1]
    v_pk_fma_f32 v[70:71], v[70:71], -2.0, v[118:119] op_sel_hi:[1,0,1]
    v_cvt_pk_bf16_f32 v32, v64, v65
    v_cvt_pk_bf16_f32 v33, v66, v67
    v_cvt_pk_bf16_f32 v34, v68, v69
    v_cvt_pk_bf16_f32 v35, v70, v71
    s_nop 0
    v_permlane16_swap_b32 v32, v34
    v_permlane16_swap_b32 v33, v35
    buffer_load_dwordx2 v[158:159], v156, s[8:11], 0 offen sc1
    v_pk_mul_f32 v[56:57], v[120:121], s[70:71]
    v_pk_mul_f32 v[58:59], v[122:123], s[70:71]
    v_pk_mul_f32 v[60:61], v[124:125], s[70:71]
    v_pk_mul_f32 v[62:63], v[126:127], s[70:71]
    v_exp_f32 v56, v56
    v_exp_f32 v57, v57
    v_exp_f32 v58, v58
    v_exp_f32 v59, v59
    v_exp_f32 v60, v60
    v_exp_f32 v61, v61
    v_exp_f32 v62, v62
    v_exp_f32 v63, v63
    v_pk_add_f32 v[56:57], v[56:57], 1.0 op_sel_hi:[1,0]
    v_pk_add_f32 v[58:59], v[58:59], 1.0 op_sel_hi:[1,0]
    v_pk_add_f32 v[60:61], v[60:61], 1.0 op_sel_hi:[1,0]
    v_pk_add_f32 v[62:63], v[62:63], 1.0 op_sel_hi:[1,0]
    v_pk_fma_f32 v[64:65], v[56:57], v[56:57], 1.0 op_sel_hi:[1,1,0]
    v_pk_fma_f32 v[66:67], v[58:59], v[58:59], 1.0 op_sel_hi:[1,1,0]
    v_pk_fma_f32 v[68:69], v[60:61], v[60:61], 1.0 op_sel_hi:[1,1,0]
    v_pk_fma_f32 v[70:71], v[62:63], v[62:63], 1.0 op_sel_hi:[1,1,0]
    v_rcp_f32 v64, v64
    v_rcp_f32 v65, v65
    v_rcp_f32 v66, v66
    v_rcp_f32 v67, v67
    v_rcp_f32 v68, v68
    v_rcp_f32 v69, v69
    v_rcp_f32 v70, v70
    v_rcp_f32 v71, v71
    v_pk_mul_f32 v[64:65], v[64:65], v[120:121]
    v_pk_mul_f32 v[66:67], v[66:67], v[122:123]
    v_pk_mul_f32 v[68:69], v[68:69], v[124:125]
    v_pk_mul_f32 v[70:71], v[70:71], v[126:127]
    v_pk_fma_f32 v[64:65], v[64:65], -2.0, v[120:121] op_sel_hi:[1,0,1]
    v_pk_fma_f32 v[66:67], v[66:67], -2.0, v[122:123] op_sel_hi:[1,0,1]
    v_pk_fma_f32 v[68:69], v[68:69], -2.0, v[124:125] op_sel_hi:[1,0,1]
    v_pk_fma_f32 v[70:71], v[70:71], -2.0, v[126:127] op_sel_hi:[1,0,1]
    v_cvt_pk_bf16_f32 v36, v64, v65
    v_cvt_pk_bf16_f32 v37, v66, v67
    v_cvt_pk_bf16_f32 v38, v68, v69
    v_cvt_pk_bf16_f32 v39, v70, v71
    s_nop 0
    v_permlane16_swap_b32 v36, v38
    v_permlane16_swap_b32 v37, v39
    v_pk_mul_f32 v[56:57], v[128:129], s[70:71]
    v_pk_mul_f32 v[58:59], v[130:131], s[70:71]
    v_pk_mul_f32 v[60:61], v[132:133], s[70:71]
    v_pk_mul_f32 v[62:63], v[134:135], s[70:71]
    v_exp_f32 v56, v56
    v_exp_f32 v57, v57
    v_exp_f32 v58, v58
    v_exp_f32 v59, v59
    v_exp_f32 v60, v60
    v_exp_f32 v61, v61
    v_exp_f32 v62, v62
    v_exp_f32 v63, v63
    v_pk_add_f32 v[56:57], v[56:57], 1.0 op_sel_hi:[1,0]
    v_pk_add_f32 v[58:59], v[58:59], 1.0 op_sel_hi:[1,0]
    v_pk_add_f32 v[60:61], v[60:61], 1.0 op_sel_hi:[1,0]
    v_pk_add_f32 v[62:63], v[62:63], 1.0 op_sel_hi:[1,0]
    v_pk_fma_f32 v[64:65], v[56:57], v[56:57], 1.0 op_sel_hi:[1,1,0]
    v_pk_fma_f32 v[66:67], v[58:59], v[58:59], 1.0 op_sel_hi:[1,1,0]
    v_pk_fma_f32 v[68:69], v[60:61], v[60:61], 1.0 op_sel_hi:[1,1,0]
    v_pk_fma_f32 v[70:71], v[62:63], v[62:63], 1.0 op_sel_hi:[1,1,0]
    v_rcp_f32 v64, v64
    v_rcp_f32 v65, v65
    v_rcp_f32 v66, v66
    v_rcp_f32 v67, v67
    v_rcp_f32 v68, v68
    v_rcp_f32 v69, v69
    v_rcp_f32 v70, v70
    v_rcp_f32 v71, v71
    v_pk_mul_f32 v[64:65], v[64:65], v[128:129]
    v_pk_mul_f32 v[66:67], v[66:67], v[130:131]
    v_pk_mul_f32 v[68:69], v[68:69], v[132:133]
    v_pk_mul_f32 v[70:71], v[70:71], v[134:135]
    v_pk_fma_f32 v[64:65], v[64:65], -2.0, v[128:129] op_sel_hi:[1,0,1]
    v_pk_fma_f32 v[66:67], v[66:67], -2.0, v[130:131] op_sel_hi:[1,0,1]
    v_pk_fma_f32 v[68:69], v[68:69], -2.0, v[132:133] op_sel_hi:[1,0,1]
    v_pk_fma_f32 v[70:71], v[70:71], -2.0, v[134:135] op_sel_hi:[1,0,1]
    v_cvt_pk_bf16_f32 v40, v64, v65
    v_cvt_pk_bf16_f32 v41, v66, v67
    v_cvt_pk_bf16_f32 v42, v68, v69
    v_cvt_pk_bf16_f32 v43, v70, v71
    s_nop 0
    v_permlane16_swap_b32 v40, v42
    v_permlane16_swap_b32 v41, v43
    s_waitcnt vmcnt(0)
L_epb:
    v_cmp_ne_u32 vcc, 0, v154
    s_cbranch_vccnz L_epokb
    v_mov_b32 v3, 0
    buffer_load_dwordx2 v[154:155], v3, s[12:15], 0 offen sc1
    s_sub_u32 s20, s20, 1
    s_waitcnt vmcnt(0)
    s_cbranch_scc0 L_epb
    s_mov_b32 s20, 0
L_epokb:
L_b_try:
    v_cmp_ne_u64 vcc, v[158:159], v[154:155]
    s_nop 0
    s_cmp_eq_u64 vcc, 0
    s_cbranch_scc1 L_b_go
    s_sleep 8
    buffer_load_dwordx2 v[158:159], v156, s[8:11], 0 offen sc1
    s_sub_u32 s20, s20, 1
    s_waitcnt vmcnt(0)
    s_cbranch_scc0 L_b_try
    s_mov_b32 s20, 0
L_b_go:
    s_lshl_b32 s22, s17, 10
    v_xor_b32 v5, s22, v1
    s_mov_b32 m0, s35
    s_mov_b32 s31, 0
    buffer_load_dwordx4 v[8:11], v5, s[8:11], s34 offen sc1
    v_xor_b32 v6, 1024, v5
    buffer_load_dwordx4 v[12:15], v6, s[8:11], s34 offen sc1
    v_xor_b32 v6, 2048, v5
    buffer_load_dwordx4 v[16:19], v6, s[8:11], s34 offen sc1
    v_xor_b32 v6, 3072, v5
    buffer_load_dwordx4 v[20:23], v6, s[8:11], s34 offen sc1
L_preb:
    buffer_load_dwordx4 v1, s[24:27], s30 offen sc1 lds
    s_add_u32 m0, m0, 1024
    s_add_u32 s31, s31, 1
    buffer_load_dwordx4 v2, s[24:27], s30 offen sc1 lds
    s_add_u32 m0, m0, 1024
    s_add_u32 s30, s30, 1024
    s_cmp_lt_u32 s31, 6
    s_cbranch_scc1 L_preb
    s_lshl_b32 s21, s29, 2
    s_add_u32 s21, s21, s17
    s_lshl_b32 s21, s21, 7
    s_add_u32 s21, s21, 8388608
    v_and_b32 v3, 31, v0
    v_lshlrev_b32 v3, 2, v3
    buffer_load_dword v7, v3, s[8:11], s21 offen sc1
    buffer_store_dwordx4 v[24:27], v1, s[8:11], s63 offen offset:0 sc1
    buffer_store_dwordx4 v[28:31], v1, s[8:11], s63 offen offset:1024 sc1
    buffer_store_dwordx4 v[32:35], v1, s[8:11], s63 offen offset:2048 sc1
    buffer_store_dwordx4 v[36:39], v1, s[8:11], s63 offen offset:3072 sc1
    buffer_store_dwordx4 v[40:43], v1, s[8:11], s64 offen offset:0 sc1
    v_pk_mul_f32 v[56:57], v[136:137], s[70:71]
    v_pk_mul_f32 v[58:59], v[138:139], s[70:71]
    v_pk_mul_f32 v[60:61], v[140:141], s[70:71]
    v_pk_mul_f32 v[62:63], v[142:143], s[70:71]
    v_exp_f32 v56, v56
    v_exp_f32 v57, v57
    v_exp_f32 v58, v58
    v_exp_f32 v59, v59
    v_exp_f32 v60, v60
    v_exp_f32 v61, v61
    v_exp_f32 v62, v62
    v_exp_f32 v63, v63
    v_pk_add_f32 v[56:57], v[56:57], 1.0 op_sel_hi:[1,0]
    v_pk_add_f32 v[58:59], v[58:59], 1.0 op_sel_hi:[1,0]
    v_pk_add_f32 v[60:61], v[60:61], 1.0 op_sel_hi:[1,0]
    v_pk_add_f32 v[62:63], v[62:63], 1.0 op_sel_hi:[1,0]
    v_pk_fma_f32 v[64:65], v[56:57], v[56:57], 1.0 op_sel_hi:[1,1,0]
    v_pk_fma_f32 v[66:67], v[58:59], v[58:59], 1.0 op_sel_hi:[1,1,0]
    v_pk_fma_f32 v[68:69], v[60:61], v[60:61], 1.0 op_sel_hi:[1,1,0]
    v_pk_fma_f32 v[70:71], v[62:63], v[62:63], 1.0 op_sel_hi:[1,1,0]
    v_rcp_f32 v64, v64
    v_rcp_f32 v65, v65
    v_rcp_f32 v66, v66
    v_rcp_f32 v67, v67
    v_rcp_f32 v68, v68
    v_rcp_f32 v69, v69
    v_rcp_f32 v70, v70
    v_rcp_f32 v71, v71
    v_pk_mul_f32 v[64:65], v[64:65], v[136:137]
    v_pk_mul_f32 v[66:67], v[66:67], v[138:139]
    v_pk_mul_f32 v[68:69], v[68:69], v[140:141]
    v_pk_mul_f32 v[70:71], v[70:71], v[142:143]
    v_pk_fma_f32 v[64:65], v[64:65], -2.0, v[136:137] op_sel_hi:[1,0,1]
    v_pk_fma_f32 v[66:67], v[66:67], -2.0, v[138:139] op_sel_hi:[1,0,1]
    v_pk_fma_f32 v[68:69], v[68:69], -2.0, v[140:141] op_sel_hi:[1,0,1]
    v_pk_fma_f32 v[70:71], v[70:71], -2.0, v[142:143] op_sel_hi:[1,0,1]
    v_cvt_pk_bf16_f32 v44, v64, v65
    v_cvt_pk_bf16_f32 v45, v66, v67
    v_cvt_pk_bf16_f32 v46, v68, v69
    v_cvt_pk_bf16_f32 v47, v70, v71
    s_nop 0
    v_permlane16_swap_b32 v44, v46
    v_permlane16_swap_b32 v45, v47
    buffer_store_dwordx4 v[44:47], v1, s[8:11], s64 offen offset:1024 sc1
    v_pk_mul_f32 v[56:57], v[144:145], s[70:71]
    v_pk_mul_f32 v[58:59], v[146:147], s[70:71]
    v_pk_mul_f32 v[60:61], v[148:149], s[70:71]
    v_pk_mul_f32 v[62:63], v[150:151], s[70:71]
    v_exp_f32 v56, v56
    v_exp_f32 v57, v57
    v_exp_f32 v58, v58
    v_exp_f32 v59, v59
    v_exp_f32 v60, v60
    v_exp_f32 v61, v61
    v_exp_f32 v62, v62
    v_exp_f32 v63, v63
    v_pk_add_f32 v[56:57], v[56:57], 1.0 op_sel_hi:[1,0]
    v_pk_add_f32 v[58:59], v[58:59], 1.0 op_sel_hi:[1,0]
    v_pk_add_f32 v[60:61], v[60:61], 1.0 op_sel_hi:[1,0]
    v_pk_add_f32 v[62:63], v[62:63], 1.0 op_sel_hi:[1,0]
    v_pk_fma_f32 v[64:65], v[56:57], v[56:57], 1.0 op_sel_hi:[1,1,0]
    v_pk_fma_f32 v[66:67], v[58:59], v[58:59], 1.0 op_sel_hi:[1,1,0]
    v_pk_fma_f32 v[68:69], v[60:61], v[60:61], 1.0 op_sel_hi:[1,1,0]
    v_pk_fma_f32 v[70:71], v[62:63], v[62:63], 1.0 op_sel_hi:[1,1,0]
    v_rcp_f32 v64, v64
    v_rcp_f32 v65, v65
    v_rcp_f32 v66, v66
    v_rcp_f32 v67, v67
    v_rcp_f32 v68, v68
    v_rcp_f32 v69, v69
    v_rcp_f32 v70, v70
    v_rcp_f32 v71, v71
    v_pk_mul_f32 v[64:65], v[64:65], v[144:145]
    v_pk_mul_f32 v[66:67], v[66:67], v[146:147]
    v_pk_mul_f32 v[68:69], v[68:69], v[148:149]
    v_pk_mul_f32 v[70:71], v[70:71], v[150:151]
    v_pk_fma_f32 v[64:65], v[64:65], -2.0, v[144:145] op_sel_hi:[1,0,1]
    v_pk_fma_f32 v[66:67], v[66:67], -2.0, v[146:147] op_sel_hi:[1,0,1]
    v_pk_fma_f32 v[68:69], v[68:69], -2.0, v[148:149] op_sel_hi:[1,0,1]
    v_pk_fma_f32 v[70:71], v[70:71], -2.0, v[150:151] op_sel_hi:[1,0,1]
    v_cvt_pk_bf16_f32 v48, v64, v65
    v_cvt_pk_bf16_f32 v49, v66, v67
    v_cvt_pk_bf16_f32 v50, v68, v69
    v_cvt_pk_bf16_f32 v51, v70, v71
    s_nop 0
    v_permlane16_swap_b32 v48, v50
    v_permlane16_swap_b32 v49, v51
    buffer_store_dwordx4 v[48:51], v1, s[8:11], s64 offen offset:2048 sc1
    s_nop 2
L_at_body:
    v_add_u32 v152, s35, v1
    v_and_b32 v3, 15, v0
    v_lshlrev_b32 v3, 4, v3
    v_lshrrev_b32 v4, 5, v0
    v_lshl_add_u32 v3, v4, 8, v3
    v_add_u32 v153, s35, v3
    v_and_b32 v4, 27, v0
    v_cmp_eq_u32 vcc, 16, v4
    v_mov_b32 v4, 0x3f803f80
    s_nop 0
    v_cndmask_b32 v4, 0, v4, vcc
    v_mov_b32 v32, v4
    v_mov_b32 v33, v4
    v_mov_b32 v34, v4
    v_mov_b32 v35, v4
    v_mov_b32 v36, v4
    v_mov_b32 v37, v4
    v_mov_b32 v38, v4
    v_mov_b32 v39, v4
    v_mov_b32 v40, v4
    v_mov_b32 v41, v4
    v_mov_b32 v42, v4
    v_mov_b32 v43, v4
    v_mov_b32 v44, v4
    v_mov_b32 v45, v4
    v_mov_b32 v46, v4
    v_mov_b32 v47, v4
    v_mov_b32 v52, 0
    v_mov_b32 v53, 0
    v_mov_b32 v54, 0
    v_mov_b32 v55, 0
    s_nop 1
    v_mfma_f32_32x32x16_bf16 v[88:103], v[52:55], v[52:55], 0
    v_mfma_f32_32x32x16_bf16 v[104:119], v[52:55], v[52:55], 0
    v_mfma_f32_32x32x16_bf16 v[120:135], v[52:55], v[52:55], 0
    v_mfma_f32_32x32x16_bf16 v[136:151], v[52:55], v[52:55], 0
    s_mov_b32 s31, 0
    s_mov_b32 s36, s35
    s_waitcnt vmcnt(11)
    ds_read_b128 v[24:27], v152 offset:0
    s_mov_b64 exec, s[32:33]
    ds_read_b128 v[32:35], v153 offset:1024
    ds_read_b128 v[36:39], v153 offset:1536
    s_mov_b64 exec, -1
    s_waitcnt lgkmcnt(0)
    v_mfma_f32_32x32x16_bf16 v[56:71], v[24:27], v[8:11], 0
    s_add_u32 m0, s36, 0
    s_setprio 3
    buffer_load_dwordx4 v1, s[24:27], s30 offen sc1 lds
    s_add_u32 m0, s36, 1024
    s_nop 0
    buffer_load_dwordx4 v2, s[24:27], s30 offen sc1 lds
    s_setprio 1
    s_add_u32 s30, s30, 1024
    s_nop 7
.p2align 6
L_at_loop:
    v_exp_f32 v56, v56
    v_exp_f32 v57, v57
    v_mfma_f32_32x32x16_bf16 v[136:151], v[44:47], v[52:55], v[136:151]
    v_exp_f32 v58, v58
    v_exp_f32 v59, v59
    v_exp_f32 v60, v60
    v_exp_f32 v61, v61
    v_mfma_f32_32x32x16_bf16 v[72:87], v[24:27], v[12:15], 0
    v_exp_f32 v62, v62
    v_exp_f32 v63, v63
    v_cvt_pk_bf16_f32 v48, v56, v57
    v_cvt_pk_bf16_f32 v49, v58, v59
    v_cvt_pk_bf16_f32 v50, v60, v61
    v_cvt_pk_bf16_f32 v51, v62, v63
    v_exp_f32 v64, v64
    v_exp_f32 v65, v65
    v_mfma_f32_32x32x16_bf16 v[88:103], v[32:35], v[48:51], v[88:103]
    v_exp_f32 v66, v66
    v_exp_f32 v67, v67
    v_exp_f32 v68, v68
    v_exp_f32 v69, v69
    v_exp_f32 v70, v70
    v_exp_f32 v71, v71
    v_cvt_pk_bf16_f32 v52, v64, v65
    v_cvt_pk_bf16_f32 v53, v66, v67
    v_cvt_pk_bf16_f32 v54, v68, v69
    v_cvt_pk_bf16_f32 v55, v70, v71
    v_exp_f32 v72, v72
    v_exp_f32 v73, v73
    v_mfma_f32_32x32x16_bf16 v[88:103], v[36:39], v[52:55], v[88:103]
    s_waitcnt vmcnt(10)
    ds_read_b128 v[28:31], v152 offset:2048
    s_mov_b64 exec, s[32:33]
    ds_read_b128 v[40:43], v153 offset:3072
    ds_read_b128 v[44:47], v153 offset:3584
    s_mov_b64 exec, -1
    v_exp_f32 v74, v74
    v_exp_f32 v75, v75
    v_exp_f32 v76, v76
    v_exp_f32 v77, v77
    v_mfma_f32_32x32x16_bf16 v[56:71], v[24:27], v[16:19], 0
    v_exp_f32 v78, v78
    v_exp_f32 v79, v79
    v_cvt_pk_bf16_f32 v48, v72, v73
    v_cvt_pk_bf16_f32 v49, v74, v75
    v_cvt_pk_bf16_f32 v50, v76, v77
    v_cvt_pk_bf16_f32 v51, v78, v79
    v_exp_f32 v80, v80
    v_exp_f32 v81, v81
    v_mfma_f32_32x32x16_bf16 v[104:119], v[32:35], v[48:51], v[104:119]
    v_exp_f32 v82, v82
    v_exp_f32 v83, v83
    v_exp_f32 v84, v84
    v_exp_f32 v85, v85
    v_exp_f32 v86, v86
    v_exp_f32 v87, v87
    v_cvt_pk_bf16_f32 v52, v80, v81
    v_cvt_pk_bf16_f32 v53, v82, v83
    v_cvt_pk_bf16_f32 v54, v84, v85
    v_cvt_pk_bf16_f32 v55, v86, v87
    v_exp_f32 v56, v56
    v_exp_f32 v57, v57
    v_mfma_f32_32x32x16_bf16 v[104:119], v[36:39], v[52:55], v[104:119]
    v_exp_f32 v58, v58
    v_exp_f32 v59, v59
    v_exp_f32 v60, v60
    v_exp_f32 v61, v61
    v_mfma_f32_32x32x16_bf16 v[72:87], v[24:27], v[20:23], 0
    v_exp_f32 v62, v62
    v_exp_f32 v63, v63
    v_cvt_pk_bf16_f32 v48, v56, v57
    v_cvt_pk_bf16_f32 v49, v58, v59
    v_cvt_pk_bf16_f32 v50, v60, v61
    v_cvt_pk_bf16_f32 v51, v62, v63
    v_exp_f32 v64, v64
    v_exp_f32 v65, v65
    v_mfma_f32_32x32x16_bf16 v[120:135], v[32:35], v[48:51], v[120:135]
    v_exp_f32 v66, v66
    v_exp_f32 v67, v67
    v_exp_f32 v68, v68
    v_exp_f32 v69, v69
    v_exp_f32 v70, v70
    v_exp_f32 v71, v71
    v_cvt_pk_bf16_f32 v52, v64, v65
    v_cvt_pk_bf16_f32 v53, v66, v67
    v_cvt_pk_bf16_f32 v54, v68, v69
    v_cvt_pk_bf16_f32 v55, v70, v71
    v_exp_f32 v72, v72
    v_exp_f32 v73, v73
    v_mfma_f32_32x32x16_bf16 v[120:135], v[36:39], v[52:55], v[120:135]
    s_cmp_eq_u32 s31, s42
    s_cbranch_scc1 L_at_flag
L_at_flagret:
    v_exp_f32 v74, v74
    v_exp_f32 v75, v75
    v_exp_f32 v76, v76
    v_exp_f32 v77, v77
    s_waitcnt lgkmcnt(0)
    v_mfma_f32_32x32x16_bf16 v[56:71], v[28:31], v[8:11], 0
    s_add_u32 m0, s36, 2048
    s_setprio 3
    buffer_load_dwordx4 v1, s[24:27], s30 offen sc1 lds
    s_add_u32 m0, s36, 3072
    s_nop 0
    buffer_load_dwordx4 v2, s[24:27], s30 offen sc1 lds
    s_setprio 1
    s_add_u32 s30, s30, 1024
    v_exp_f32 v78, v78
    v_exp_f32 v79, v79
    v_cvt_pk_bf16_f32 v48, v72, v73
    v_cvt_pk_bf16_f32 v49, v74, v75
    v_cvt_pk_bf16_f32 v50, v76, v77
    v_cvt_pk_bf16_f32 v51, v78, v79
    v_exp_f32 v80, v80
    v_exp_f32 v81, v81
    v_mfma_f32_32x32x16_bf16 v[136:151], v[32:35], v[48:51], v[136:151]
    v_exp_f32 v82, v82
    v_exp_f32 v83, v83
    v_exp_f32 v84, v84
    v_exp_f32 v85, v85
    v_exp_f32 v86, v86
    v_exp_f32 v87, v87
    v_cvt_pk_bf16_f32 v52, v80, v81
    v_cvt_pk_bf16_f32 v53, v82, v83
    v_cvt_pk_bf16_f32 v54, v84, v85
    v_cvt_pk_bf16_f32 v55, v86, v87
    v_exp_f32 v56, v56
    v_exp_f32 v57, v57
    v_mfma_f32_32x32x16_bf16 v[136:151], v[36:39], v[52:55], v[136:151]
    s_add_u32 s21, s36, 4096
    s_add_u32 s22, s35, 12288
    s_cmp_eq_u32 s21, s22
    s_cselect_b32 s21, s35, s21
    s_sub_u32 s37, s21, s36
    s_mov_b32 s36, s21
    v_add_u32 v152, s37, v152
    v_add_u32 v153, s37, v153
    v_exp_f32 v58, v58
    v_exp_f32 v59, v59
    v_exp_f32 v60, v60
    v_exp_f32 v61, v61
    v_mfma_f32_32x32x16_bf16 v[72:87], v[28:31], v[12:15], 0
    v_exp_f32 v62, v62
    v_exp_f32 v63, v63
    v_cvt_pk_bf16_f32 v48, v56, v57
    v_cvt_pk_bf16_f32 v49, v58, v59
    v_cvt_pk_bf16_f32 v50, v60, v61
    v_cvt_pk_bf16_f32 v51, v62, v63
    v_exp_f32 v64, v64
    v_exp_f32 v65, v65
    v_mfma_f32_32x32x16_bf16 v[88:103], v[40:43], v[48:51], v[88:103]
    v_exp_f32 v66, v66
    v_exp_f32 v67, v67
    v_exp_f32 v68, v68
    v_exp_f32 v69, v69
    v_exp_f32 v70, v70
    v_exp_f32 v71, v71
    v_cvt_pk_bf16_f32 v52, v64, v65
    v_cvt_pk_bf16_f32 v53, v66, v67
    v_cvt_pk_bf16_f32 v54, v68, v69
    v_cvt_pk_bf16_f32 v55, v70, v71
    v_exp_f32 v72, v72
    v_exp_f32 v73, v73
    v_mfma_f32_32x32x16_bf16 v[88:103], v[44:47], v[52:55], v[88:103]
    s_waitcnt vmcnt(10)
    ds_read_b128 v[24:27], v152 offset:0
    s_mov_b64 exec, s[32:33]
    ds_read_b128 v[32:35], v153 offset:1024
    ds_read_b128 v[36:39], v153 offset:1536
    s_mov_b64 exec, -1
    v_exp_f32 v74, v74
    v_exp_f32 v75, v75
    v_exp_f32 v76, v76
    v_exp_f32 v77, v77
    v_mfma_f32_32x32x16_bf16 v[56:71], v[28:31], v[16:19], 0
    v_exp_f32 v78, v78
    v_exp_f32 v79, v79
    v_cvt_pk_bf16_f32 v48, v72, v73
    v_cvt_pk_bf16_f32 v49, v74, v75
    v_cvt_pk_bf16_f32 v50, v76, v77
    v_cvt_pk_bf16_f32 v51, v78, v79
    v_exp_f32 v80, v80
    v_exp_f32 v81, v81
    v_mfma_f32_32x32x16_bf16 v[104:119], v[40:43], v[48:51], v[104:119]
    v_exp_f32 v82, v82
    v_exp_f32 v83, v83
    v_exp_f32 v84, v84
    v_exp_f32 v85, v85
    v_exp_f32 v86, v86
    v_exp_f32 v87, v87
    v_cvt_pk_bf16_f32 v52, v80, v81
    v_cvt_pk_bf16_f32 v53, v82, v83
    v_cvt_pk_bf16_f32 v54, v84, v85
    v_cvt_pk_bf16_f32 v55, v86, v87
    v_exp_f32 v56, v56
    v_exp_f32 v57, v57
    v_mfma_f32_32x32x16_bf16 v[104:119], v[44:47], v[52:55], v[104:119]
    v_exp_f32 v58, v58
    v_exp_f32 v59, v59
    v_exp_f32 v60, v60
    v_exp_f32 v61, v61
    v_mfma_f32_32x32x16_bf16 v[72:87], v[28:31], v[20:23], 0
    v_exp_f32 v62, v62
    v_exp_f32 v63, v63
    v_cvt_pk_bf16_f32 v48, v56, v57
    v_cvt_pk_bf16_f32 v49, v58, v59
    v_cvt_pk_bf16_f32 v50, v60, v61
    v_cvt_pk_bf16_f32 v51, v62, v63
    v_exp_f32 v64, v64
    v_exp_f32 v65, v65
    v_mfma_f32_32x32x16_bf16 v[120:135], v[40:43], v[48:51], v[120:135]
    v_exp_f32 v66, v66
    v_exp_f32 v67, v67
    v_exp_f32 v68, v68
    v_exp_f32 v69, v69
    v_exp_f32 v70, v70
    v_exp_f32 v71, v71
    v_cvt_pk_bf16_f32 v52, v64, v65
    v_cvt_pk_bf16_f32 v53, v66, v67
    v_cvt_pk_bf16_f32 v54, v68, v69
    v_cvt_pk_bf16_f32 v55, v70, v71
    v_exp_f32 v72, v72
    v_exp_f32 v73, v73
    v_mfma_f32_32x32x16_bf16 v[120:135], v[44:47], v[52:55], v[120:135]
    v_exp_f32 v74, v74
    v_exp_f32 v75, v75
    v_exp_f32 v76, v76
    v_exp_f32 v77, v77
    s_waitcnt lgkmcnt(0)
    v_mfma_f32_32x32x16_bf16 v[56:71], v[24:27], v[8:11], 0
    s_cmp_ge_u32 s31, 4
    s_cselect_b32 s26, 0, s26
    s_add_u32 m0, s36, 0
    s_setprio 3
    buffer_load_dwordx4 v1, s[24:27], s30 offen sc1 lds
    s_add_u32 m0, s36, 1024
    s_nop 0
    buffer_load_dwordx4 v2, s[24:27], s30 offen sc1 lds
    s_setprio 1
    s_add_u32 s30, s30, 1024
    v_exp_f32 v78, v78
    v_exp_f32 v79, v79
    v_cvt_pk_bf16_f32 v48, v72, v73
    v_cvt_pk_bf16_f32 v49, v74, v75
    v_cvt_pk_bf16_f32 v50, v76, v77
    v_cvt_pk_bf16_f32 v51, v78, v79
    v_exp_f32 v80, v80
    v_exp_f32 v81, v81
    v_mfma_f32_32x32x16_bf16 v[136:151], v[40:43], v[48:51], v[136:151]
    v_exp_f32 v82, v82
    v_exp_f32 v83, v83
    v_exp_f32 v84, v84
    v_exp_f32 v85, v85
    v_exp_f32 v86, v86
    v_exp_f32 v87, v87
    v_cvt_pk_bf16_f32 v52, v80, v81
    v_cvt_pk_bf16_f32 v53, v82, v83
    v_cvt_pk_bf16_f32 v54, v84, v85
    v_cvt_pk_bf16_f32 v55, v86, v87
    s_add_u32 s31, s31, 1
    s_cmp_lt_u32 s31, 8
    s_cbranch_scc1 L_at_loop
    v_mfma_f32_32x32x16_bf16 v[136:151], v[44:47], v[52:55], v[136:151]
    s_setprio 3
    v_add_u32 v3, s35, v1
    v_lshlrev_b32 v4, 2, v0
    v_add_u32 v5, s35, v4
    s_waitcnt vmcnt(0)
    ds_write_b128 v3, v[104:107] offset:0
    ds_write_b128 v3, v[108:111] offset:1024
    ds_write_b32 v5, v112 offset:2048
    ds_write_b128 v3, v[120:123] offset:2304
    ds_write_b128 v3, v[124:127] offset:3328
    ds_write_b32 v5, v128 offset:4352
    s_nop 0
    ds_write_b128 v3, v[136:139] offset:4608
    ds_write_b128 v3, v[140:143] offset:5632
    ds_write_b32 v5, v144 offset:6656
    v_mov_b32 v5, s39
    v_mov_b32 v6, 1
    s_waitcnt lgkmcnt(0)
    s_mov_b64 exec, 1
    ds_add_u32 v5, v6
    s_mov_b64 exec, -1
L_at_gs:
    s_sleep 1
    ds_read_b32 v6, v5
    s_sub_u32 s20, s20, 1
    s_cselect_b32 s22, 4, 0
    s_waitcnt lgkmcnt(0)
    v_readfirstlane_b32 s21, v6
    s_nop 0
    s_add_u32 s21, s21, s22
    s_cmp_lt_u32 s21, 4
    s_cbranch_scc1 L_at_gs
    s_xor_b32 s21, s17, 1
    s_mul_i32 s21, s21, 12288
    s_add_u32 s21, s21, s38
    v_add_u32 v3, s21, v1
    v_add_u32 v5, s21, v4
    ds_read_b128 v[104:107], v3 offset:0
    ds_read_b128 v[108:111], v3 offset:1024
    ds_read_b32 v112, v5 offset:2048
    s_xor_b32 s21, s17, 2
    s_mul_i32 s21, s21, 12288
    s_add_u32 s21, s21, s38
    v_add_u32 v3, s21, v1
    v_add_u32 v5, s21, v4
    ds_read_b128 v[120:123], v3 offset:2304
    ds_read_b128 v[124:127], v3 offset:3328
    ds_read_b32 v128, v5 offset:4352
    s_xor_b32 s21, s17, 3
    s_mul_i32 s21, s21, 12288
    s_add_u32 s21, s21, s38
    v_add_u32 v3, s21, v1
    v_add_u32 v5, s21, v4
    ds_read_b128 v[136:139], v3 offset:4608
    ds_read_b128 v[140:143], v3 offset:5632
    ds_read_b32 v144, v5 offset:6656
    s_waitcnt lgkmcnt(0)
    v_pk_add_f32 v[88:89], v[88:89], v[104:105]
    v_pk_add_f32 v[120:121], v[120:121], v[136:137]
    v_pk_add_f32 v[90:91], v[90:91], v[106:107]
    v_pk_add_f32 v[122:123], v[122:123], v[138:139]
    v_pk_add_f32 v[92:93], v[92:93], v[108:109]
    v_pk_add_f32 v[124:125], v[124:125], v[140:141]
    v_pk_add_f32 v[94:95], v[94:95], v[110:111]
    v_pk_add_f32 v[126:127], v[126:127], v[142:143]
    v_add_f32 v96, v96, v112
    v_add_f32 v128, v128, v144
    v_pk_add_f32 v[88:89], v[88:89], v[120:121]
    v_pk_add_f32 v[90:91], v[90:91], v[122:123]
    v_pk_add_f32 v[92:93], v[92:93], v[124:125]
    v_pk_add_f32 v[94:95], v[94:95], v[126:127]
    v_add_f32 v96, v96, v128
    v_mov_b32 v5, v96
    v_fma_f32 v5, v88, 0, v5
    v_fma_f32 v5, v89, 0, v5
    v_fma_f32 v5, v90, 0, v5
    v_fma_f32 v5, v91, 0, v5
    v_fma_f32 v5, v92, 0, v5
    v_fma_f32 v5, v93, 0, v5
    v_fma_f32 v5, v94, 0, v5
    v_fma_f32 v5, v95, 0, v5
    s_mov_b32 s21, 0x30800000
    s_mov_b32 s22, 0x4e800000
    v_cmp_le_f32 vcc, s21, v5
    v_cmp_ge_f32 s[40:41], s22, v5
    s_nop 0
    s_and_b64 vcc, vcc, s[40:41]
    s_cmp_eq_u64 vcc, -1
    s_cbranch_scc0 L_at_slow
L_at_fin:
    v_rcp_f32 v5, v96
    s_lshl_b32 s21, s29, 2
    s_add_u32 s21, s21, s17
    s_lshl_b32 s21, s21, 5
    s_add_u32 s21, s21, s28
    s_lshl_b32 s21, s21, 10
    s_add_u32 s21, s21, 6291456
    v_mul_f32 v5, v5, v7
    v_mul_f32 v88, v88, v5
    v_mul_f32 v89, v89, v5
    v_mul_f32 v90, v90, v5
    v_mul_f32 v91, v91, v5
    v_mul_f32 v92, v92, v5
    v_mul_f32 v93, v93, v5
    v_mul_f32 v94, v94, v5
    v_mul_f32 v95, v95, v5
    v_cvt_pk_bf16_f32 v48, v88, v89
    v_cvt_pk_bf16_f32 v49, v90, v91
    v_cvt_pk_bf16_f32 v50, v92, v93
    v_cvt_pk_bf16_f32 v51, v94, v95
    v_min_u32 v48, -2, v48
    v_min_u32 v49, -2, v49
    v_min_u32 v50, -2, v50
    v_min_u32 v51, -2, v51
    s_nop 0
    v_permlane32_swap_b32 v48, v50
    v_permlane32_swap_b32 v49, v51
    buffer_store_dwordx4 v[48:51], v1, s[8:11], s21 offen sc1
    s_endpgm
L_at_flag:
    s_waitcnt vmcnt(2)
    v_mov_b32 v3, 0
    s_mov_b64 exec, 1
    buffer_store_dwordx2 v[154:155], v3, s[8:11], s43 offen sc1
    s_mov_b64 exec, -1
    s_branch L_at_flagret
L_at_slow:
    s_lshl_b32 s22, s28, 16
    s_add_u32 s22, s22, 2097152
    s_mov_b32 s30, s22
    s_mov_b32 s31, 0
    v_mov_b32 v6, 0xff800000
    v_and_b32 v3, 15, v0
    v_lshlrev_b32 v3, 4, v3
    v_lshrrev_b32 v4, 5, v0
    v_lshl_add_u32 v3, v4, 8, v3
    v_add_u32 v2, 2097152, v3
L_at_slow1:
    buffer_load_dwordx4 v[24:27], v1, s[8:11], s30 offen sc1
    s_add_u32 s30, s30, 1024
    s_waitcnt vmcnt(0)
    v_mfma_f32_32x32x16_bf16 v[56:71], v[24:27], v[8:11], 0
    s_nop 11
    v_max3_f32 v6, v6, v56, v57
    v_max3_f32 v6, v6, v58, v59
    v_max3_f32 v6, v6, v60, v61
    v_max3_f32 v6, v6, v62, v63
    v_max3_f32 v6, v6, v64, v65
    v_max3_f32 v6, v6, v66, v67
    v_max3_f32 v6, v6, v68, v69
    v_max3_f32 v6, v6, v70, v71
    s_add_u32 s31, s31, 1
    s_cmp_lt_u32 s31, 64
    s_cbranch_scc1 L_at_slow1
    v_mov_b32 v3, v6
    v_mov_b32 v4, v6
    s_nop 1
    v_permlane32_swap_b32 v3, v4
    v_max_f32 v6, v3, v4
    s_mov_b32 s30, s22
    s_mov_b32 s31, 0
    v_mov_b32 v88, 0
    v_mov_b32 v89, 0
    v_mov_b32 v90, 0
    v_mov_b32 v91, 0
    v_mov_b32 v92, 0
    v_mov_b32 v93, 0
    v_mov_b32 v94, 0
    v_mov_b32 v95, 0
    v_mov_b32 v96, 0
    v_mov_b32 v97, 0
    v_mov_b32 v98, 0
    v_mov_b32 v99, 0
    v_mov_b32 v100, 0
    v_mov_b32 v101, 0
    v_mov_b32 v102, 0
    v_mov_b32 v103, 0
L_at_slow2:
    buffer_load_dwordx4 v[24:27], v1, s[8:11], s30 offen sc1
    s_mov_b64 exec, s[32:33]
    buffer_load_dwordx4 v[32:35], v2, s[8:11], s30 offen sc1
    buffer_load_dwordx4 v[36:39], v2, s[8:11], s30 offen offset:512 sc1
    s_mov_b64 exec, -1
    s_add_u32 s30, s30, 1024
    s_waitcnt vmcnt(0)
    v_mfma_f32_32x32x16_bf16 v[56:71], v[24:27], v[8:11], 0
    s_nop 11
    v_sub_f32 v56, v56, v6
    v_sub_f32 v57, v57, v6
    v_sub_f32 v58, v58, v6
    v_sub_f32 v59, v59, v6
    v_sub_f32 v60, v60, v6
    v_sub_f32 v61, v61, v6
    v_sub_f32 v62, v62, v6
    v_sub_f32 v63, v63, v6
    v_sub_f32 v64, v64, v6
    v_sub_f32 v65, v65, v6
    v_sub_f32 v66, v66, v6
    v_sub_f32 v67, v67, v6
    v_sub_f32 v68, v68, v6
    v_sub_f32 v69, v69, v6
    v_sub_f32 v70, v70, v6
    v_sub_f32 v71, v71, v6
    v_exp_f32 v56, v56
    v_exp_f32 v57, v57
    v_exp_f32 v58, v58
    v_exp_f32 v59, v59
    v_exp_f32 v60, v60
    v_exp_f32 v61, v61
    v_exp_f32 v62, v62
    v_exp_f32 v63, v63
    v_exp_f32 v64, v64
    v_exp_f32 v65, v65
    v_exp_f32 v66, v66
    v_exp_f32 v67, v67
    v_exp_f32 v68, v68
    v_exp_f32 v69, v69
    v_exp_f32 v70, v70
    v_exp_f32 v71, v71
    v_cvt_pk_bf16_f32 v48, v56, v57
    v_cvt_pk_bf16_f32 v49, v58, v59
    v_cvt_pk_bf16_f32 v50, v60, v61
    v_cvt_pk_bf16_f32 v51, v62, v63
    v_cvt_pk_bf16_f32 v52, v64, v65
    v_cvt_pk_bf16_f32 v53, v66, v67
    v_cvt_pk_bf16_f32 v54, v68, v69
    v_cvt_pk_bf16_f32 v55, v70, v71
    v_mfma_f32_32x32x16_bf16 v[88:103], v[32:35], v[48:51], v[88:103]
    s_nop 0
    v_mfma_f32_32x32x16_bf16 v[88:103], v[36:39], v[52:55], v[88:103]
    s_nop 7
    s_add_u32 s31, s31, 1
    s_cmp_lt_u32 s31, 64
    s_cbranch_scc1 L_at_slow2
    s_nop 15
    s_branch L_at_fin
L_end:
    s_endpgm
L_code_end:
.section .rodata,"a"
.p2align 6
.amdhsa_kernel gated_mix__softmax_full_mha__dense_activation_mish__prompt_kernel
  .amdhsa_next_free_vgpr 160
  .amdhsa_next_free_sgpr 88
  .amdhsa_accum_offset 160
  .amdhsa_group_segment_fixed_size 0
  .amdhsa_kernarg_size 88
  .amdhsa_user_sgpr_count 2
  .amdhsa_user_sgpr_kernarg_segment_ptr 1
  .amdhsa_system_sgpr_workgroup_id_x 1
.end_amdhsa_kernel
```
